```python
import torch

def _softmax(x, axis=-1):
    return torch.softmax(x, dim=axis)
def _gelu(x):
    return torch.nn.functional.gelu(x, approximate="tanh")
def _silu(x):
    return torch.nn.functional.silu(x)
def _sigmoid(x):
    return torch.sigmoid(x)
def _layernorm(x, axis=-1, eps=1e-5):
    m = x.mean(dim=axis, keepdim=True)
    v = x.var(dim=axis, keepdim=True, unbiased=False)
    return (x - m) / torch.sqrt(v + eps)
def _scatter_add(tgt, idx, src, axis=0):
    return tgt.clone().index_add_(axis, idx, src)
def _segment_sum(src, seg, n):
    out = torch.zeros((n,) + src.shape[1:], dtype=src.dtype)
    return out.index_add_(0, seg, src)
def _pad(x, pw):
    flat = tuple(v for pair in reversed(pw) for v in pair)
    return torch.nn.functional.pad(x, flat)

kernel_name = 'parallel_sum__compressed_kv_cla__glu_gated_bilinear__decode'

def setup_inputs():

    _w = (lambda a: (lambda t: t.to(torch.bfloat16) if t.is_floating_point() else t)(torch.as_tensor(a)))
    def _A_setup():
        B, H, Sq, Sk, D, M = 1, 32, 1, 16384, 128, 512
        Dc = 4 * D
        return {
            "x": _w((lambda *s: torch.randn(*s, dtype=torch.bfloat16) * 0.05)(B, Sq, M)),
            "c_kv": _w((lambda *s: torch.randn(*s, dtype=torch.bfloat16) * 0.8)(B, Sk, Dc)),
            "w_q": _w((lambda *s: torch.randn(*s, dtype=torch.bfloat16) * 1.6)(M, H, D) * (M ** -0.5)),
            "w_uk": _w((lambda *s: torch.randn(*s, dtype=torch.bfloat16) * 1.6)(Dc, H, D) * (Dc ** -0.5)),
            "w_uv": _w((lambda *s: torch.randn(*s, dtype=torch.bfloat16) * 0.8)(Dc, H, D) * (Dc ** -0.5)),
            "w_o": _w((lambda *s: torch.randn(*s, dtype=torch.bfloat16) * 0.8)(H, D, M) * ((H * D) ** -0.5)),
        }
    _A_in = _A_setup()

    def _B_setup():
        B, S, D, F = 1, 1, 512, 1376
        return {
            "x": _w((lambda *s: torch.randn(*s, dtype=torch.bfloat16) * 0.05)(B, S, D)),
            "w_gate": _w((lambda *s: torch.randn(*s, dtype=torch.bfloat16) * 0.4)(D, F) * (D ** -0.5)),
            "w_up": _w((lambda *s: torch.randn(*s, dtype=torch.bfloat16) * 0.4)(D, F) * (D ** -0.5)),
            "w_down": _w((lambda *s: torch.randn(*s, dtype=torch.bfloat16) * 0.4)(F, D) * (F ** -0.5)),
        }
    _B_in = _B_setup()

    return {
        "A_x": _A_in["x"],
        "A_c_kv": _A_in["c_kv"],
        "A_w_q": _A_in["w_q"],
        "A_w_uk": _A_in["w_uk"],
        "A_w_uv": _A_in["w_uv"],
        "A_w_o": _A_in["w_o"],
        "B_x": _B_in["x"],
        "B_w_gate": _B_in["w_gate"],
        "B_w_up": _B_in["w_up"],
        "B_w_down": _B_in["w_down"],
    }

def reference(A_x, A_c_kv, A_w_q, A_w_uk, A_w_uv, A_w_o, B_x, B_w_gate, B_w_up, B_w_down):
    def _A_ref(x, c_kv, w_q, w_uk, w_uv, w_o):
        B, Sq, M = x.shape[0], x.shape[1], x.shape[2]
        Sk = c_kv.shape[1]
        H, D = w_q.shape[1], w_q.shape[2]
        q = torch.einsum("bqm,mhd->bhqd", x, w_q)
        k = torch.einsum("bkc,chd->bhkd", c_kv, w_uk)
        v = torch.einsum("bkc,chd->bhkd", c_kv, w_uv)
        scores = torch.einsum("bhqd,bhkd->bhqk", q, k) * (D ** -0.5)
        off = Sk - Sq
        qi = torch.arange(Sq)[:, None]
        kj = torch.arange(Sk)[None, :]
        cmask = kj <= (qi + off)
        scores = torch.where(cmask[None, None], scores, -1e9)
        p = _softmax(scores, axis=-1)
        ctx = torch.einsum("bhqk,bhkd->bhqd", p, v)
        return torch.einsum("bhqd,hdm->bqm", ctx, w_o)

    def _B_ref(x, w_gate, w_up, w_down):
        g = torch.einsum("bsd,df->bsf", x, w_gate)
        u = torch.einsum("bsd,df->bsf", x, w_up)
        h = g * u
        return torch.einsum("bsf,fd->bsd", h, w_down)

    x = A_x
    xn = _layernorm(x, axis=-1)
    return x + _A_ref(xn, A_c_kv, A_w_q, A_w_uk, A_w_uv, A_w_o) + _B_ref(xn, B_w_gate, B_w_up, B_w_down)
```

```asm
; @launch grid=(256,1,1) block=(512,1,1) lds=163840
.amdgcn_target "amdgcn-amd-amdhsa--gfx950"
.text
.globl parallel_sum__compressed_kv_cla__glu_gated_bilinear__decode_kernel
.p2align 8
.type parallel_sum__compressed_kv_cla__glu_gated_bilinear__decode_kernel,@function
parallel_sum__compressed_kv_cla__glu_gated_bilinear__decode_kernel:
    s_load_dwordx8 s[12:19], s[0:1], 0
    s_load_dwordx2 s[4:5], s[0:1], 96
    v_lshrrev_b32 v1, 6, v0
    s_cmpk_ge_u32 s2, 256
    v_readfirstlane_b32 s3, v1
    s_cbranch_scc1 L_end
    s_lshr_b32 s41, s2, 3
    s_cmp_lt_u32 s3, 4
    s_cbranch_scc1 L_e1
    s_getpc_b64 s[50:51]
    v_lshl_add_u32 v1, s41, 8, v0
    v_lshlrev_b32 v1, 1, v1
    global_load_ushort v59, v1, s[50:51] offset:-512
    s_branch L_hi
L_e1:
    s_and_b32 s40, s2, 7
    s_lshr_b32 s42, s2, 6
    s_lshl2_add_u32 s42, s40, s42
    s_and_b32 s43, s41, 7
    s_xor_b32 s43, s43, 1
    s_and_b32 s51, s3, 2
    s_lshl2_add_u32 s50, s43, s51
    s_and_b32 s51, s3, 1
    s_lshl4_add_u32 s50, s50, s51
    s_lshl_b32 s50, s50, 5
    s_add_u32 s50, s50, s42
    s_lshl_b32 s50, s50, 8
    v_and_b32 v2, 63, v0
    v_lshrrev_b32 v11, 4, v2
    v_and_b32 v12, 15, v2
    v_lshlrev_b32 v3, 4, v2
    v_lshlrev_b32 v10, 1, v11
    v_xor_b32 v10, v10, v12
    v_lshlrev_b32 v10, 4, v10
    v_lshl_add_u32 v10, v11, 16, v10
    v_xor_b32 v13, 0x80, v10
    s_add_u32 s51, s3, 32
    s_lshl_b32 m0, s51, 12
    s_cmp_lg_u32 s3, 0
    s_waitcnt lgkmcnt(0)
    s_cbranch_scc1 L_e2
    global_load_dwordx4 v[4:7], v3, s[12:13]
L_e2:
    s_lshl_b32 s18, 1, 22
    s_mov_b32 s19, 0x20000
    buffer_load_dwordx4 v10, s[16:19], s50 offen offset:0 lds
    s_addk_i32 s50, 15360
    buffer_load_dwordx4 v13, s[16:19], s50 offen offset:1024 lds
    s_addk_i32 s50, 15360
    buffer_load_dwordx4 v10, s[16:19], s50 offen offset:2048 lds
    s_addk_i32 s50, 15360
    buffer_load_dwordx4 v13, s[16:19], s50 offen offset:3072 lds
.p2align 8
    s_branch L_front
L_hi:
    s_and_b32 s40, s2, 7
    s_lshr_b32 s42, s2, 6
    s_lshl2_add_u32 s42, s40, s42
    s_and_b32 s43, s41, 7
    s_xor_b32 s43, s43, 1
    s_and_b32 s51, s3, 2
    s_lshl2_add_u32 s50, s43, s51
    s_and_b32 s51, s3, 1
    s_lshl4_add_u32 s50, s50, s51
    s_lshl_b32 s50, s50, 5
    s_add_u32 s50, s50, s42
    s_lshl_b32 s50, s50, 8
    v_and_b32 v2, 63, v0
    v_lshrrev_b32 v11, 4, v2
    v_and_b32 v12, 15, v2
    v_lshlrev_b32 v3, 4, v2
    v_lshlrev_b32 v10, 1, v11
    v_xor_b32 v10, v10, v12
    v_lshlrev_b32 v10, 4, v10
    v_lshl_add_u32 v10, v11, 16, v10
    v_xor_b32 v13, 0x80, v10
    s_add_u32 s51, s3, 32
    s_lshl_b32 m0, s51, 12
    s_waitcnt lgkmcnt(0)
    s_mov_b64 s[16:17], s[18:19]
    s_lshl_b32 s18, 1, 22
    s_mov_b32 s19, 0x20000
    buffer_load_dwordx4 v10, s[16:19], s50 offen offset:0 lds
    s_addk_i32 s50, 15360
    buffer_load_dwordx4 v13, s[16:19], s50 offen offset:1024 lds
    s_addk_i32 s50, 15360
    buffer_load_dwordx4 v10, s[16:19], s50 offen offset:2048 lds
    s_addk_i32 s50, 15360
    buffer_load_dwordx4 v13, s[16:19], s50 offen offset:3072 lds
L_front:
    s_load_dword s46, s[4:5], 0
    s_load_dwordx2 s[8:9], s[0:1], 24
    s_mov_b32 s6, 268435456
    s_mov_b32 s7, 0x20000
    v_lshrrev_b32 v61, 2, v12
    v_lshlrev_b32 v61, 7, v61
    v_and_b32 v1, 3, v2
    v_lshl_add_u32 v61, v1, 2, v61
    s_lshl3_add_u32 s53, s42, s3
    s_lshl_b32 s53, s53, 5
    s_add_u32 s53, s53, s43
    s_lshl_b32 s53, s53, 4
    s_add_u32 s53, s53, 6422528
    s_lshl3_add_u32 s54, s42, s43
    s_lshl3_add_u32 s54, s54, s3
    s_lshl_b32 s54, s54, 6
    s_add_u32 s54, s54, 6291456
    s_lshr_b32 s90, s43, 1
    v_lshrrev_b32 v8, 3, v2
    v_and_b32 v9, 7, v2
    v_lshlrev_b32 v58, 2, v2
    v_lshlrev_b32 v23, 6, v12
    v_and_b32 v57, 12, v2
    v_lshl_add_u32 v57, v1, 4, v57
    v_lshrrev_b32 v30, 2, v2
    v_and_b32 v31, 7, v30
    v_xor_b32 v31, s3, v31
    v_lshlrev_b32 v31, 5, v31
    v_lshl_add_u32 v31, v30, 8, v31
    v_and_b32 v30, 3, v2
    v_lshl_add_u32 v52, v30, 3, v31
    v_add_u32 v60, 131072, v52
    s_and_b32 s51, s43, 1
    s_lshl_b32 s51, s51, 7
    s_add_u32 s51, s51, 130560
    v_lshl_add_u32 v56, v11, 4, s51
    s_cmp_eq_u32 s3, 0
    s_cbranch_scc1 L_ln
    s_bitcmp1_b32 s41, 0
    s_cbranch_scc1 L_bpre
    s_branch L_apre
L_ln:
    v_add_u32 v1, 129024, v3
    s_lshl_b32 s51, s90, 8
    s_add_u32 s51, s51, 129024
    v_lshl_add_u32 v15, v2, 1, s51
    v_bfe_u32 v44, v2, 1, 2
    v_and_b32 v45, 1, v2
    v_lshl_add_u32 v44, v44, 1, v45
    v_and_b32 v45, 3, v8
    v_lshl_add_u32 v44, v44, 2, v45
    v_and_or_b32 v44, v2, 32, v44
    v_lshlrev_b32 v44, 1, v44
    v_add_u32 v44, 130560, v44
    v_add_u32 v45, 130048, v58
    s_waitcnt vmcnt(4)
    ds_write_b128 v1, v[4:7]
    ds_read_u16 v14, v15
    ds_read_u16 v15, v15 offset:128
    v_lshlrev_b32 v32, 16, v4
    v_and_b32 v33, 0xffff0000, v4
    v_lshlrev_b32 v34, 16, v5
    v_and_b32 v35, 0xffff0000, v5
    v_lshlrev_b32 v36, 16, v6
    v_and_b32 v37, 0xffff0000, v6
    v_lshlrev_b32 v38, 16, v7
    v_and_b32 v39, 0xffff0000, v7
    v_add_f32 v40, v32, v33
    v_add_f32 v41, v34, v35
    v_add_f32 v42, v36, v37
    v_add_f32 v43, v38, v39
    v_add_f32 v40, v40, v41
    v_add_f32 v42, v42, v43
    v_add_f32 v40, v40, v42
    s_nop 1
    v_add_f32_dpp v40, v40, v40 row_ror:8 row_mask:0xf bank_mask:0xf
    s_nop 1
    v_add_f32_dpp v40, v40, v40 row_ror:4 row_mask:0xf bank_mask:0xf
    s_nop 1
    v_add_f32_dpp v40, v40, v40 row_ror:2 row_mask:0xf bank_mask:0xf
    s_nop 1
    v_add_f32_dpp v40, v40, v40 row_ror:1 row_mask:0xf bank_mask:0xf
    v_mov_b32 v41, v40
    s_nop 1
    v_permlane16_swap_b32 v40, v41
    v_add_f32 v40, v40, v41
    v_mov_b32 v41, v40
    s_nop 1
    v_permlane32_swap_b32 v40, v41
    v_add_f32 v40, v40, v41
    v_mul_f32 v40, 0x3b000000, v40
    v_sub_f32 v32, v32, v40
    v_sub_f32 v33, v33, v40
    v_sub_f32 v34, v34, v40
    v_sub_f32 v35, v35, v40
    v_sub_f32 v36, v36, v40
    v_sub_f32 v37, v37, v40
    v_sub_f32 v38, v38, v40
    v_sub_f32 v39, v39, v40
    v_mul_f32 v42, v32, v32
    v_fmac_f32 v42, v33, v33
    v_fmac_f32 v42, v34, v34
    v_fmac_f32 v42, v35, v35
    v_fmac_f32 v42, v36, v36
    v_fmac_f32 v42, v37, v37
    v_fmac_f32 v42, v38, v38
    v_fmac_f32 v42, v39, v39
    s_nop 1
    v_add_f32_dpp v42, v42, v42 row_ror:8 row_mask:0xf bank_mask:0xf
    s_nop 1
    v_add_f32_dpp v42, v42, v42 row_ror:4 row_mask:0xf bank_mask:0xf
    s_nop 1
    v_add_f32_dpp v42, v42, v42 row_ror:2 row_mask:0xf bank_mask:0xf
    s_nop 1
    v_add_f32_dpp v42, v42, v42 row_ror:1 row_mask:0xf bank_mask:0xf
    v_mov_b32 v41, v42
    s_nop 1
    v_permlane16_swap_b32 v42, v41
    v_add_f32 v42, v42, v41
    v_mov_b32 v41, v42
    s_nop 1
    v_permlane32_swap_b32 v42, v41
    v_add_f32 v42, v42, v41
    v_mul_f32 v42, 0x3b000000, v42
    v_cvt_pk_bf16_f32 v42, v42, v42
    v_and_b32 v42, 0xffff0000, v42
    v_cvt_pk_bf16_f32 v40, v40, v40
    v_and_b32 v40, 0xffff0000, v40
    v_add_f32 v42, 0x3727c5ac, v42
    v_cvt_pk_bf16_f32 v42, v42, v42
    v_and_b32 v42, 0xffff0000, v42
    v_sqrt_f32 v42, v42
    s_waitcnt lgkmcnt(0)
    v_lshlrev_b32 v14, 16, v14
    v_sub_f32 v14, v14, v40
    v_lshlrev_b32 v15, 16, v15
    v_sub_f32 v15, v15, v40
    v_cvt_pk_bf16_f32 v42, v42, v42
    v_and_b32 v42, 0xffff0000, v42
    v_rcp_f32 v43, v42
    v_cvt_pk_bf16_f32 v14, v14, v14
    v_and_b32 v14, 0xffff0000, v14
    v_cvt_pk_bf16_f32 v15, v15, v15
    v_and_b32 v15, 0xffff0000, v15
    v_mul_f32 v41, v14, v43
    v_fma_f32 v14, -v41, v42, v14
    v_fma_f32 v14, v14, v43, v41
    v_cvt_pk_bf16_f32 v14, v14, v14
    v_mul_f32 v41, v15, v43
    v_fma_f32 v15, -v41, v42, v15
    v_fma_f32 v15, v15, v43, v41
    v_cvt_pk_bf16_f32 v15, v15, v15
    ds_write_b16 v44, v14
    ds_write_b16 v44, v15 offset:128
    ds_write2st64_b32 v45, v14, v15 offset1:1
    s_bitcmp1_b32 s41, 0
    s_cbranch_scc0 L_apre
L_stagea:
    s_waitcnt lgkmcnt(0)
    s_add_u32 s46, s46, 1
    s_and_b32 s47, s46, 0xff
    v_mov_b32 v1, s47
    s_movk_i32 s51, 0xff
    s_cmp_lt_u32 s3, 4
    s_cbranch_scc0 L_sa1
    s_waitcnt vmcnt(0)
    s_bitcmp1_b32 s41, 0
    s_cbranch_scc0 L_sa1
    s_mov_b64 s[16:17], s[8:9]
    s_add_u32 s50, s50, 478208
    s_sub_u32 m0, m0, 49152
    s_nop 0
    buffer_load_dwordx4 v10, s[16:19], s50 offen offset:0 lds
    s_addk_i32 s50, 15360
    buffer_load_dwordx4 v13, s[16:19], s50 offen offset:1024 lds
    s_addk_i32 s50, 15360
    buffer_load_dwordx4 v10, s[16:19], s50 offen offset:2048 lds
    s_addk_i32 s50, 15360
    buffer_load_dwordx4 v13, s[16:19], s50 offen offset:3072 lds
L_sa1:
    s_barrier
    ds_read_b128 v[32:35], v56
    ds_read_b64_tr_b16 v[40:41], v60 offset:0
    ds_read_b64_tr_b16 v[42:43], v60 offset:4096
    ds_read_b64_tr_b16 v[44:45], v60 offset:8192
    ds_read_b64_tr_b16 v[46:47], v60 offset:12288
    ds_read_b128 v[36:39], v56 offset:64
    s_waitcnt lgkmcnt(3)
    v_mfma_f32_16x16x32_bf16 v[28:31], v[32:35], v[40:43], 0
    s_waitcnt lgkmcnt(0)
    v_mfma_f32_16x16x32_bf16 v[28:31], v[36:39], v[44:47], v[28:31]
    s_mov_b64 exec, 0xffff
    s_bitcmp1_b32 s41, 0
    s_nop 5
    v_bfi_b32 v28, s51, v1, v28
    buffer_store_dword v28, v61, s[4:7], s53 offen
    s_mov_b64 exec, -1
    s_barrier
    s_cbranch_scc0 L_attn
    s_cmp_lt_u32 s3, 4
    s_cbranch_scc0 L_gath
    s_waitcnt vmcnt(0)
    s_mov_b64 exec, 0xffff
    buffer_store_dword v28, v58, s[4:7], s54 offen sc1
    s_mov_b64 exec, -1
    s_barrier
    s_branch L_wtail
L_gath:
    s_mov_b32 s48, 0
h1_1:
    buffer_load_dwordx4 v[32:35], v14, s[4:7], s55 offen sc1
    s_waitcnt vmcnt(0)
    v_xor_b32 v32, s47, v32
    v_xor_b32 v33, s47, v33
    v_xor_b32 v34, s47, v34
    v_xor_b32 v35, s47, v35
    v_or_b32 v5, v32, v33
    v_or3_b32 v5, v5, v34, v35
    v_and_b32 v5, 0xff, v5
    v_cmp_ne_u32 vcc, 0, v5
    v_add_f32_dpp v32, v32, v32 quad_perm:[1,0,3,2] row_mask:0xf bank_mask:0xf
    v_add_f32_dpp v33, v33, v33 quad_perm:[1,0,3,2] row_mask:0xf bank_mask:0xf
    s_cbranch_vccnz rt_2
ok_3:
    v_add_f32_dpp v34, v34, v34 quad_perm:[1,0,3,2] row_mask:0xf bank_mask:0xf
    v_add_f32_dpp v35, v35, v35 quad_perm:[1,0,3,2] row_mask:0xf bank_mask:0xf
    v_add_f32_dpp v32, v32, v32 quad_perm:[2,3,0,1] row_mask:0xf bank_mask:0xf
    v_add_f32_dpp v33, v33, v33 quad_perm:[2,3,0,1] row_mask:0xf bank_mask:0xf
    v_add_f32_dpp v34, v34, v34 quad_perm:[2,3,0,1] row_mask:0xf bank_mask:0xf
    v_add_f32_dpp v35, v35, v35 quad_perm:[2,3,0,1] row_mask:0xf bank_mask:0xf
    v_add_f32_dpp v32, v32, v32 row_half_mirror row_mask:0xf bank_mask:0xf
    v_add_f32_dpp v33, v33, v33 row_half_mirror row_mask:0xf bank_mask:0xf
    v_add_f32_dpp v34, v34, v34 row_half_mirror row_mask:0xf bank_mask:0xf
    v_add_f32_dpp v35, v35, v35 row_half_mirror row_mask:0xf bank_mask:0xf
    v_cvt_pk_bf16_f32 v32, v32, v33
    v_cvt_pk_bf16_f32 v33, v34, v35
    ds_write_b64 v20, v[32:33]
    s_waitcnt lgkmcnt(0)
    s_barrier
    ds_read_b128 v[32:35], v21 offset:0
    ds_read_b128 v[64:67], v16 offset:0
    ds_read_b128 v[68:71], v16 offset:4096
    ds_read_b128 v[36:39], v21 offset:64
    ds_read_b128 v[72:75], v17 offset:0
    ds_read_b128 v[76:79], v17 offset:4096
    ds_read_b128 v[40:43], v21 offset:128
    ds_read_b128 v[80:83], v18 offset:0
    ds_read_b128 v[84:87], v18 offset:4096
    ds_read_b128 v[44:47], v21 offset:192
    ds_read_b128 v[88:91], v19 offset:0
    ds_read_b128 v[92:95], v19 offset:4096
    s_waitcnt lgkmcnt(9)
    v_mfma_f32_16x16x32_bf16 v[96:99], v[32:35], v[64:67], 0
    v_mfma_f32_16x16x32_bf16 v[100:103], v[32:35], v[68:71], 0
    s_waitcnt lgkmcnt(6)
    v_mfma_f32_16x16x32_bf16 v[96:99], v[36:39], v[72:75], v[96:99]
    v_mfma_f32_16x16x32_bf16 v[100:103], v[36:39], v[76:79], v[100:103]
    s_waitcnt lgkmcnt(3)
    v_mfma_f32_16x16x32_bf16 v[96:99], v[40:43], v[80:83], v[96:99]
    v_mfma_f32_16x16x32_bf16 v[100:103], v[40:43], v[84:87], v[100:103]
    s_waitcnt lgkmcnt(0)
    v_mfma_f32_16x16x32_bf16 v[96:99], v[44:47], v[88:91], v[96:99]
    v_mfma_f32_16x16x32_bf16 v[100:103], v[44:47], v[92:95], v[100:103]
    s_mov_b64 exec, 0xffff
    s_nop 5
    v_mul_f32 v96, 0x340293ee, v96
    v_mul_f32 v100, 0x340293ee, v100
    v_cvt_pk_bf16_f32 v96, v96, v100
    v_xor_b32 v96, v96, v22
    buffer_store_dword v96, v57, s[4:7], s60 offen sc1
    s_mov_b64 exec, 0xffff
    buffer_store_dword v28, v58, s[4:7], s54 offen sc1
    s_mov_b64 exec, -1
    s_branch L_wtail
L_bpre:
    s_and_b32 s44, s3, 3
    s_lshl_b32 s55, s42, 12
    s_add_u32 s55, s55, 6291456
    s_lshl_b32 s51, s44, 10
    s_add_u32 s51, s51, 131072
    v_add_u32 v14, s51, v3
    v_lshlrev_b32 v15, 9, v9
    v_lshl_add_u32 v15, v8, 4, v15
    s_lshl_b32 s51, s44, 7
    v_add_u32 v15, s51, v15
    s_add_u32 s51, s90, 4
    s_cmp_eq_u32 s3, s51
    s_cbranch_scc0 L_noin
    buffer_load_dwordx4 v[104:107], v14, s[4:7], s55 offen sc1
L_noin:
    s_lshl_b32 s51, s44, 6
    s_add_u32 s51, s51, 130816
    v_lshl_add_u32 v20, v8, 3, s51
    v_lshlrev_b32 v21, 4, v11
    v_add_u32 v21, 130816, v21
    s_and_b32 s51, s44, 1
    s_lshl_b32 s51, s51, 13
    s_and_b32 s56, s44, 2
    s_lshl_b32 s56, s56, 15
    s_sub_u32 s51, s51, s56
    s_add_u32 s51, s51, 147456
    v_lshl_add_u32 v5, v12, 8, s51
    v_lshlrev_b32 v6, 1, v9
    v_xor_b32 v6, v6, v11
    v_xor_b32 v16, 0, v6
    v_lshl_add_u32 v16, v16, 4, v5
    v_xor_b32 v17, 4, v6
    v_lshl_add_u32 v17, v17, 4, v5
    v_xor_b32 v18, 8, v6
    v_lshl_add_u32 v18, v18, 4, v5
    v_xor_b32 v19, 12, v6
    v_lshl_add_u32 v19, v19, 4, v5
    s_lshl3_add_u32 s49, s42, s43
    s_lshl1_add_u32 s49, s49, s44
    s_lshl_b32 s60, s49, 6
    s_add_u32 s60, s60, 262144
    v_lshrrev_b32 v5, 5, v2
    v_lshl_add_u32 v23, v5, 16, v23
    s_lshl_b32 s59, s42, 6
    s_add_u32 s59, s59, s90
    s_lshl_b32 s59, s59, 4
    s_add_u32 s59, s59, 524288
    s_cmp_eq_u32 s3, 5
    s_cbranch_scc0 L_noclr
    v_mov_b32 v24, -1
    v_mov_b32 v25, -1
    v_mov_b32 v26, -1
    v_mov_b32 v27, -1
    buffer_store_dwordx4 v[24:27], v23, s[4:7], s59 offen sc1
    s_lshl2_add_u32 s56, s42, s90
    s_lshl_b32 s56, s56, 9
    s_add_u32 s56, s56, 458752
    s_lshl_b32 s57, s90, 5
    s_add_u32 s57, s57, s42
    s_lshl_b32 s57, s57, 9
    s_add_u32 s57, s57, 785920
    s_sub_u32 s57, s57, s56
    v_mul_lo_u32 v5, v5, s57
    v_add_u32 v5, v5, v3
    buffer_store_dwordx4 v[24:27], v5, s[4:7], s56 offen sc1
L_noclr:
    s_and_b32 s51, s3, 1
    v_and_b32 v5, 3, v2
    v_and_b32 v6, 12, v2
    v_lshl_add_u32 v5, s51, 2, v5
    v_mul_u32_u24 v5, 33, v5
    s_waitcnt lgkmcnt(0)
    v_add3_u32 v5, v5, s46, 1
    v_lshrrev_b32 v6, 1, v6
    v_lshrrev_b32 v5, v6, v5
    v_bfe_u32 v22, v5, 0, 1
    v_lshlrev_b32 v22, 14, v22
    v_bfe_u32 v6, v5, 1, 1
    v_lshl_or_b32 v22, v6, 30, v22
    s_branch L_stagea
L_wtail:
    s_load_dwordx2 s[24:25], s[0:1], 32
    s_load_dwordx2 s[32:33], s[0:1], 56
    s_load_dwordx2 s[36:37], s[0:1], 64
    s_mov_b32 s26, 4194304
    s_mov_b32 s27, 0x20000
    s_mov_b32 s34, 1409024
    s_mov_b32 s35, 0x20000
    s_mov_b32 s38, 1409024
    s_mov_b32 s39, 0x20000
    v_and_b32 v1, 1, v2
    v_cmp_eq_u32 vcc, 1, v1
    v_mov_b32 v1, 0xffff
    v_mov_b32 v16, 0xffff0000
    v_cndmask_b32 v1, v1, v16, vcc
    v_bfe_u32 v19, v2, 1, 2
    v_cmp_eq_u32 vcc, 0, v19
    s_nop 1
    v_cndmask_b32 v16, 0, v1, vcc
    v_cmp_eq_u32 vcc, 1, v19
    s_nop 1
    v_cndmask_b32 v17, 0, v1, vcc
    v_cmp_eq_u32 vcc, 2, v19
    s_nop 1
    v_cndmask_b32 v18, 0, v1, vcc
    v_cmp_eq_u32 vcc, 3, v19
    s_nop 1
    v_cndmask_b32 v19, 0, v1, vcc
    v_cmp_gt_u32 vcc, 8, v12
    s_nop 1
    v_cndmask_b32 v24, 0, v16, vcc
    v_cndmask_b32 v25, 0, v17, vcc
    v_cndmask_b32 v26, 0, v18, vcc
    v_cndmask_b32 v27, 0, v19, vcc
    v_mul_u32_u24 v4, 33, v9
    v_add_u32 v4, s46, v4
    v_bfe_u32 v20, v4, 0, 1
    v_lshlrev_b32 v20, 14, v20
    v_bfe_u32 v5, v4, 1, 1
    v_lshl_or_b32 v20, v5, 30, v20
    v_bfe_u32 v21, v4, 2, 1
    v_lshlrev_b32 v21, 14, v21
    v_bfe_u32 v5, v4, 3, 1
    v_lshl_or_b32 v21, v5, 30, v21
    v_bfe_u32 v22, v4, 4, 1
    v_lshlrev_b32 v22, 14, v22
    v_bfe_u32 v5, v4, 5, 1
    v_lshl_or_b32 v22, v5, 30, v22
    v_bfe_u32 v23, v4, 6, 1
    v_lshlrev_b32 v23, 14, v23
    v_bfe_u32 v5, v4, 7, 1
    v_lshl_or_b32 v23, v5, 30, v23
    s_cmp_lt_u32 s40, 3
    s_cselect_b32 s56, 6, 5
    s_cselect_b32 s57, 0, 12
    s_mul_i32 s51, s42, s56
    s_add_u32 s57, s57, s51
    v_lshlrev_b32 v50, 1, v11
    v_xor_b32 v50, v50, v12
    v_lshlrev_b32 v50, 4, v50
    v_lshl_add_u32 v50, v11, 17, v50
    v_xor_b32 v51, 0x80, v50
    v_mul_u32_u24 v10, 5504, v8
    v_lshl_add_u32 v10, v9, 4, v10
    v_bfrev_b32 v5, 1
    v_cmp_gt_u32 vcc, s56, v9
    s_nop 1
    v_cndmask_b32 v10, v5, v10, vcc
    s_and_b32 s51, s3, 1
    s_lshl1_add_u32 s50, s90, s51
    s_lshl_b32 s50, s50, 5
    s_and_b32 s51, s3, 6
    s_add_u32 s50, s50, s51
    s_lshl_b32 s50, s50, 14
    s_lshl_b32 s51, s42, 8
    s_add_u32 s58, s50, s51
    s_lshl3_add_u32 s50, s90, s3
    s_mul_i32 s50, s50, 44032
    s_lshl_b32 s51, s57, 4
    s_add_u32 s61, s50, s51
    s_and_b32 s50, s42, 3
    s_bfe_u32 s53, s42, 0x20002
    s_lshl2_add_u32 s50, s50, s53
    s_lshl_b32 s50, s50, 8
    s_lshl_b32 s53, s3, 19
    s_add_u32 s50, s50, s53
    s_add_u32 s80, s50, 8388608
    s_xor_b32 s81, s80, 0x8400
    s_xor_b32 s82, s80, 0x10800
    s_xor_b32 s83, s80, 0x18c00
    s_lshr_b32 s53, s42, 4
    s_lshl1_add_u32 s53, s90, s53
    s_and_b32 s51, s3, 1
    s_lshl_b32 s51, s51, 2
    s_xor_b32 s53, s53, s51
    v_xor_b32 v5, s53, v11
    v_lshlrev_b32 v7, 17, v11
    v_lshl_add_u32 v7, v12, 4, v7
    v_lshl_add_u32 v7, v5, 12, v7
    s_lshl2_add_u32 s84, s42, s90
    s_lshl_b32 s84, s84, 9
    s_add_u32 s84, s84, 458752
    s_and_b32 s51, s3, 1
    s_lshl1_add_u32 s85, s42, s51
    s_lshr_b32 s51, s3, 1
    s_lshl3_add_u32 s85, s85, s51
    s_lshl2_add_u32 s85, s85, s90
    s_lshl_b32 s85, s85, 4
    s_add_u32 s85, s85, 524288
    s_xor_b32 s86, s85, 0x10000
    v_lshlrev_b32 v62, 8, v8
    v_lshl_add_u32 v62, v9, 1, v62
    s_lshl_b32 s55, s42, 4
    s_lshl_b32 s51, s3, 13
    s_add_u32 s55, s55, s51
    s_add_u32 s55, s55, 393216
    v_lshl_add_u32 v54, v11, 2, v12
    s_lshl_b32 s53, s3, 7
    v_lshl_add_u32 v55, v54, 3, s53
    v_lshlrev_b32 v54, 9, v54
    v_lshlrev_b32 v53, 3, v2
    v_and_b32 v57, 1, v11
    v_lshlrev_b32 v57, 4, v57
    v_lshl_add_u32 v57, v9, 5, v57
    v_lshrrev_b32 v6, 5, v2
    v_lshl_add_u32 v57, v6, 8, v57
    s_lshl_b32 s53, s3, 9
    v_add_u32 v57, s53, v57
    s_mul_i32 s53, s3, 288
    v_lshlrev_b32 v63, 4, v12
    v_lshl_add_u32 v63, v11, 3, v63
    v_add_u32 v63, s53, v63
    v_mul_u32_u24 v4, 288, v9
    v_lshl_add_u32 v4, v11, 4, v4
    s_lshl_b32 s59, s3, 12
    s_add_u32 s59, s59, 32768
    s_lshl_b32 s50, s3, 6
    s_add_u32 s50, s50, 130048
    v_lshl_add_u32 v1, v8, 3, s50
    ds_read_b64 v[32:33], v1
    s_waitcnt lgkmcnt(0)
    v_and_b32 v64, v32, v16
    v_and_b32 v65, v32, v17
    v_and_b32 v66, v32, v18
    v_and_b32 v67, v32, v19
    v_and_b32 v68, v33, v16
    v_and_b32 v69, v33, v17
    v_and_b32 v70, v33, v18
    v_and_b32 v71, v33, v19
    s_cmp_lt_u32 s3, 4
    s_cbranch_scc1 L_noqd
    s_lshl_b32 s50, s49, 2
    s_add_u32 s50, s50, 327680
    v_mov_b32 v88, s46
    s_mov_b64 exec, 1
    s_waitcnt vmcnt(0)
    buffer_store_dword v88, v3, s[4:7], s50 offen sc1
    s_mov_b64 exec, -1
L_noqd:
    s_cmp_eq_u32 s3, 3
    s_cbranch_scc0 L_go
    s_lshl_b32 s50, s40, 7
    s_add_u32 s50, s50, 655360
    v_lshlrev_b32 v5, 2, v12
    s_movk_i32 s48, 40
L_sg:
    buffer_load_dword v6, v5, s[4:7], s50 offen sc1
    s_sub_u32 s48, s48, 1
    s_cbranch_scc1 L_go
    s_waitcnt vmcnt(0)
    v_cmp_eq_u32 vcc, s46, v6
    s_nop 0
    s_bcnt1_i32_b64 s51, vcc
    s_cmp_lt_u32 s51, 8
    s_cbranch_scc1 L_sg
L_go:
    s_barrier
    buffer_load_dwordx4 v[128:131], v10, s[32:35], s61 offen offset:0
    buffer_load_dwordx4 v[132:135], v10, s[36:39], s61 offen offset:0
    buffer_load_dwordx4 v[136:139], v10, s[32:35], s61 offen offset:2752
    buffer_load_dwordx4 v[140:143], v10, s[36:39], s61 offen offset:2752
    s_barrier
    s_mov_b32 m0, s59
    s_addk_i32 s59, 1024
    buffer_load_dwordx4 v50, s[24:27], s58 offen nt lds
    s_addk_i32 s58, 8192
    s_mov_b32 m0, s59
    s_addk_i32 s59, 1024
    buffer_load_dwordx4 v51, s[24:27], s58 offen nt lds
    s_addk_i32 s58, 8192
    s_mov_b32 m0, s59
    s_addk_i32 s59, 1024
    buffer_load_dwordx4 v50, s[24:27], s58 offen nt lds
    s_addk_i32 s58, 8192
    s_mov_b32 m0, s59
    s_addk_i32 s59, 1024
    buffer_load_dwordx4 v51, s[24:27], s58 offen nt lds
    s_addk_i32 s58, 8192
    s_waitcnt vmcnt(4)
    v_mfma_f32_16x16x32_bf16 v[72:75], v[64:67], v[128:131], 0
    v_mfma_f32_16x16x32_bf16 v[76:79], v[64:67], v[132:135], 0
    v_mfma_f32_16x16x32_bf16 v[72:75], v[68:71], v[136:139], v[72:75]
    v_mfma_f32_16x16x32_bf16 v[76:79], v[68:71], v[140:143], v[76:79]
    s_nop 7
    v_permlane32_swap_b32 v72, v76
    v_permlane32_swap_b32 v73, v77
    v_permlane32_swap_b32 v74, v78
    v_permlane32_swap_b32 v75, v79
    v_add_f32_dpp v72, v76, v72 row_ror:8 row_mask:0xf bank_mask:0xf
    v_add_f32_dpp v73, v77, v73 row_ror:8 row_mask:0xf bank_mask:0xf
    v_add_f32_dpp v74, v78, v74 row_ror:8 row_mask:0xf bank_mask:0xf
    v_add_f32_dpp v75, v79, v75 row_ror:8 row_mask:0xf bank_mask:0xf
    s_mov_b32 exec_lo, 0xff00ff
    s_mov_b32 exec_hi, 0xff00ff
    ds_write_b128 v57, v[72:75] offset:0
    s_mov_b64 exec, -1
    s_cmp_eq_u32 s3, 5
    s_waitcnt lgkmcnt(0)
    s_barrier
    s_cbranch_scc0 L_nogup
    ds_read_b64 v[32:33], v53 offset:0
    ds_read_b64 v[34:35], v53 offset:512
    ds_read_b64 v[36:37], v53 offset:1024
    ds_read_b64 v[38:39], v53 offset:1536
    ds_read_b64 v[40:41], v53 offset:2048
    ds_read_b64 v[42:43], v53 offset:2560
    ds_read_b64 v[44:45], v53 offset:3072
    ds_read_b64 v[46:47], v53 offset:3584
    s_waitcnt lgkmcnt(0)
    v_add_f32 v32, v32, v40
    v_add_f32 v33, v33, v41
    v_add_f32 v34, v34, v42
    v_add_f32 v35, v35, v43
    v_add_f32 v36, v36, v44
    v_add_f32 v37, v37, v45
    v_add_f32 v38, v38, v46
    v_add_f32 v39, v39, v47
    v_add_f32 v32, v32, v36
    v_add_f32 v33, v33, v37
    v_add_f32 v34, v34, v38
    v_add_f32 v35, v35, v39
    v_add_f32 v32, v32, v34
    v_add_f32 v33, v33, v35
    v_mov_b32 v90, v32
    v_mov_b32 v91, v33
    buffer_store_dwordx2 v[90:91], v53, s[4:7], s84 offen
L_nogup:
    s_mov_b32 s52, 0x000f000f
    s_mov_b32 s53, s52
    s_mov_b32 s48, 0
    s_waitcnt vmcnt(0)
    s_cmp_eq_u32 s3, 3
    s_cbranch_scc0 L_smx
    s_lshl_b32 s50, s40, 7
    s_add_u32 s50, s50, 655424
    v_lshlrev_b32 v5, 2, v12
    s_movk_i32 s60, 24
L_sm:
    buffer_load_dword v6, v5, s[4:7], s50 offen sc1
    s_sub_u32 s60, s60, 1
    s_cbranch_scc1 L_smx
    s_waitcnt vmcnt(0)
    v_cmp_eq_u32 vcc, s46, v6
    s_nop 0
    s_bcnt1_i32_b64 s51, vcc
    s_cmp_lt_u32 s51, 64
    s_cbranch_scc1 L_sm
L_smx:
    s_barrier
L_ml:
    s_mov_b64 exec, s[52:53]
    buffer_load_dwordx4 v[28:31], v54, s[4:7], s55 offen sc1
    s_add_u32 s48, s48, 1
    s_cmp_ge_u32 s48, 65536
    s_cselect_b64 s[50:51], s[52:53], 0
    s_waitcnt vmcnt(0)
    v_cmp_eq_u32 vcc, s46, v30
    v_cmp_eq_u32 s[88:89], s46, v31
    s_nop 0
    s_and_b64 vcc, vcc, s[88:89]
    s_or_b64 vcc, vcc, s[50:51]
    s_andn2_b64 s[52:53], s[52:53], vcc
    s_cbranch_scc1 L_ml
    s_mov_b32 exec_lo, 0xf000f
    s_mov_b32 exec_hi, 0xf000f
    ds_write_b64 v55, v[28:29] offset:20480
    s_mov_b64 exec, -1
    s_waitcnt lgkmcnt(0)
    s_barrier
    buffer_load_dwordx4 v[96:99], v7, s[4:7], s80 offen sc1
    buffer_load_dwordx4 v[100:103], v7, s[4:7], s81 offen sc1
    buffer_load_dwordx4 v[104:107], v7, s[4:7], s82 offen sc1
    buffer_load_dwordx4 v[108:111], v7, s[4:7], s83 offen sc1
    ds_read_b128 v[32:35], v3 offset:20480
    ds_read_b64_tr_b16 v[192:193], v52 offset:32768
    ds_read_b64_tr_b16 v[194:195], v52 offset:36864
    ds_read_b64_tr_b16 v[196:197], v52 offset:40960
    ds_read_b64_tr_b16 v[198:199], v52 offset:45056
    ds_read_b64_tr_b16 v[200:201], v52 offset:49152
    ds_read_b64_tr_b16 v[202:203], v52 offset:53248
    ds_read_b64_tr_b16 v[204:205], v52 offset:57344
    ds_read_b64_tr_b16 v[206:207], v52 offset:61440
    s_mov_b32 s54, 0x40004000
    s_mov_b32 s48, 0
    s_mov_b64 s[88:89], -1
    s_waitcnt lgkmcnt(8)
    v_max_f32 v5, v32, v34
    s_nop 1
    v_max_f32_dpp v5, v5, v5 row_ror:8 row_mask:0xf bank_mask:0xf
    s_nop 1
    v_max_f32_dpp v5, v5, v5 row_ror:4 row_mask:0xf bank_mask:0xf
    s_nop 1
    v_max_f32_dpp v5, v5, v5 row_ror:2 row_mask:0xf bank_mask:0xf
    s_nop 1
    v_max_f32_dpp v5, v5, v5 row_ror:1 row_mask:0xf bank_mask:0xf
    v_mov_b32 v6, v5
    s_nop 1
    v_permlane16_swap_b32 v5, v6
    v_max_f32 v5, v5, v6
    v_mov_b32 v6, v5
    s_nop 1
    v_permlane32_swap_b32 v5, v6
    v_max_f32 v5, v5, v6
    v_sub_f32 v29, v28, v5
    v_sub_f32 v32, v32, v5
    v_sub_f32 v34, v34, v5
    v_exp_f32 v29, v29
    v_exp_f32 v32, v32
    v_exp_f32 v34, v34
    v_mul_f32 v28, v32, v33
    v_fmac_f32 v28, v34, v35
    s_nop 1
    v_add_f32_dpp v28, v28, v28 row_ror:8 row_mask:0xf bank_mask:0xf
    s_nop 1
    v_add_f32_dpp v28, v28, v28 row_ror:4 row_mask:0xf bank_mask:0xf
    s_nop 1
    v_add_f32_dpp v28, v28, v28 row_ror:2 row_mask:0xf bank_mask:0xf
    s_nop 1
    v_add_f32_dpp v28, v28, v28 row_ror:1 row_mask:0xf bank_mask:0xf
    v_mov_b32 v6, v28
    s_nop 1
    v_permlane16_swap_b32 v28, v6
    v_add_f32 v28, v28, v6
    v_mov_b32 v6, v28
    s_nop 1
    v_permlane32_swap_b32 v28, v6
    v_add_f32 v28, v28, v6
    v_rcp_f32 v28, v28
    s_nop 0
    v_mul_f32 v29, v29, v28
    v_cvt_pk_bf16_f32 v29, v29, v29
    s_nop 1
    v_and_b32_dpp v64, v29, v24 row_newbcast:0 row_mask:0xf bank_mask:0xf
    v_and_b32_dpp v65, v29, v25 row_newbcast:0 row_mask:0xf bank_mask:0xf
    v_and_b32_dpp v66, v29, v26 row_newbcast:0 row_mask:0xf bank_mask:0xf
    v_and_b32_dpp v67, v29, v27 row_newbcast:0 row_mask:0xf bank_mask:0xf
    v_and_b32_dpp v68, v29, v24 row_newbcast:1 row_mask:0xf bank_mask:0xf
    v_and_b32_dpp v69, v29, v25 row_newbcast:1 row_mask:0xf bank_mask:0xf
    v_and_b32_dpp v70, v29, v26 row_newbcast:1 row_mask:0xf bank_mask:0xf
    v_and_b32_dpp v71, v29, v27 row_newbcast:1 row_mask:0xf bank_mask:0xf
    v_and_b32_dpp v72, v29, v24 row_newbcast:2 row_mask:0xf bank_mask:0xf
    v_and_b32_dpp v73, v29, v25 row_newbcast:2 row_mask:0xf bank_mask:0xf
    v_and_b32_dpp v74, v29, v26 row_newbcast:2 row_mask:0xf bank_mask:0xf
    v_and_b32_dpp v75, v29, v27 row_newbcast:2 row_mask:0xf bank_mask:0xf
    v_and_b32_dpp v76, v29, v24 row_newbcast:3 row_mask:0xf bank_mask:0xf
    v_and_b32_dpp v77, v29, v25 row_newbcast:3 row_mask:0xf bank_mask:0xf
    v_and_b32_dpp v78, v29, v26 row_newbcast:3 row_mask:0xf bank_mask:0xf
    v_and_b32_dpp v79, v29, v27 row_newbcast:3 row_mask:0xf bank_mask:0xf
L_pt:
    s_waitcnt vmcnt(3)
    v_xor_b32 v96, v96, v20
    v_xor_b32 v97, v97, v21
    v_xor_b32 v98, v98, v22
    v_xor_b32 v99, v99, v23
    v_or_b32 v5, v96, v97
    v_or3_b32 v5, v5, v98, v99
    v_mfma_f32_16x16x32_bf16 v[80:83], v[64:67], v[96:99], 0
    s_waitcnt vmcnt(2)
    v_xor_b32 v100, v100, v20
    v_xor_b32 v101, v101, v21
    v_xor_b32 v102, v102, v22
    v_xor_b32 v103, v103, v23
    v_or3_b32 v5, v5, v100, v101
    v_or3_b32 v5, v5, v102, v103
    v_mfma_f32_16x16x32_bf16 v[80:83], v[68:71], v[100:103], v[80:83]
    s_waitcnt vmcnt(1)
    v_xor_b32 v104, v104, v20
    v_xor_b32 v105, v105, v21
    v_xor_b32 v106, v106, v22
    v_xor_b32 v107, v107, v23
    v_or3_b32 v5, v5, v104, v105
    v_or3_b32 v5, v5, v106, v107
    v_mfma_f32_16x16x32_bf16 v[80:83], v[72:75], v[104:107], v[80:83]
    s_waitcnt vmcnt(0)
    v_xor_b32 v108, v108, v20
    v_xor_b32 v109, v109, v21
    v_xor_b32 v110, v110, v22
    v_xor_b32 v111, v111, v23
    v_or3_b32 v5, v5, v108, v109
    v_or3_b32 v5, v5, v110, v111
    v_mfma_f32_16x16x32_bf16 v[80:83], v[76:79], v[108:111], v[80:83]
    v_and_b32 v5, s54, v5
    v_cmp_ne_u32 vcc, 0, v5
    s_nop 0
    s_and_b64 vcc, vcc, s[88:89]
    s_cbranch_vccnz L_ptslow
L_ptok:
    s_mov_b32 exec_hi, 0
    s_nop 1
    v_cvt_pk_bf16_f32 v80, v80, v81
    v_cvt_pk_bf16_f32 v81, v82, v83
    ds_write_b64 v63, v[80:81] offset:8192
    s_mov_b64 exec, -1
    s_cmp_eq_u32 s3, 5
    s_cbranch_scc0 L_gug2
    buffer_store_dwordx2 v[90:91], v53, s[4:7], s84 offen sc1
L_gug2:
    s_waitcnt lgkmcnt(0)
    s_barrier
    ds_read_b128 v[32:35], v4 offset:8192
    ds_read_b128 v[36:39], v4 offset:8256
    ds_read_b128 v[40:43], v4 offset:8320
    ds_read_b128 v[44:47], v4 offset:8384
    s_waitcnt lgkmcnt(3)
    v_mfma_f32_16x16x32_bf16 v[84:87], v[32:35], v[192:195], 0
    s_waitcnt lgkmcnt(2)
    v_mfma_f32_16x16x32_bf16 v[84:87], v[36:39], v[196:199], v[84:87]
    s_waitcnt lgkmcnt(1)
    v_mfma_f32_16x16x32_bf16 v[84:87], v[40:43], v[200:203], v[84:87]
    s_waitcnt lgkmcnt(0)
    v_mfma_f32_16x16x32_bf16 v[84:87], v[44:47], v[204:207], v[84:87]
    s_nop 7
    v_add_f32 v84, v84, v85
    v_add_f32 v86, v86, v87
    v_add_f32 v85, v84, v86
    v_add_f32 v84, v84, v86
    s_nop 1
    v_permlane16_swap_b32 v84, v85
    v_add_f32 v84, v84, v85
    s_mov_b64 exec, 0xffff
    v_cvt_pk_bf16_f32 v84, v84, v84
    buffer_store_short v84, v62, s[4:7], s86 offen
    s_barrier
    buffer_store_short v84, v62, s[4:7], s85 offen sc1
    s_branch L_fin
L_apre:
    s_mov_b64 s[20:21], s[14:15]
    s_mov_b32 s22, 16777216
    s_mov_b32 s23, 0x20000
    s_lshr_b32 s50, s41, 1
    s_lshl4_add_u32 s44, s40, s50
    s_lshl3_add_u32 s51, s40, s3
    s_lshl4_add_u32 s50, s51, s50
    s_lshl_b32 s50, s50, 10
    s_lshl_b32 s45, s3, 10
    s_lshl_b32 s51, s3, 5
    v_xor_b32 v14, s51, v3
    s_movk_i32 s60, 12
    s_cmp_lt_u32 s3, 4
    s_cbranch_scc1 L_stagea
    s_mov_b32 m0, s45
    s_addk_i32 s45, 8192
    buffer_load_dwordx4 v14, s[20:23], s50 offen nt lds
    s_add_u32 s50, s50, 0x100000
    v_xor_b32 v14, 16, v14
    s_movk_i32 s60, 11
    s_branch L_stagea
L_attn:
    s_mov_b32 m0, s45
    s_addk_i32 s45, 8192
    buffer_load_dwordx4 v14, s[20:23], s50 offen nt lds
    s_add_u32 s50, s50, 0x100000
    v_xor_b32 v14, 16, v14
    s_mov_b32 m0, s45
    s_addk_i32 s45, 8192
    buffer_load_dwordx4 v14, s[20:23], s50 offen nt lds
    s_add_u32 s50, s50, 0x100000
    v_xor_b32 v14, 16, v14
    s_mov_b32 m0, s45
    s_addk_i32 s45, 8192
    buffer_load_dwordx4 v14, s[20:23], s50 offen nt lds
    s_add_u32 s50, s50, 0x100000
    v_xor_b32 v14, 16, v14
    s_mov_b32 m0, s45
    s_addk_i32 s45, 8192
    buffer_load_dwordx4 v14, s[20:23], s50 offen nt lds
    s_add_u32 s50, s50, 0x100000
    v_xor_b32 v14, 16, v14
    s_mov_b64 exec, 0xffff
    buffer_store_dword v28, v58, s[4:7], s54 offen sc1
    s_mov_b64 exec, -1
    s_load_dwordx2 s[28:29], s[0:1], 40
    s_load_dwordx2 s[92:93], s[0:1], 72
    s_load_dwordx2 s[96:97], s[0:1], 80
    s_mov_b32 s30, 4194304
    s_mov_b32 s31, 0x20000
    s_mov_b32 s94, 1409024
    s_mov_b32 s95, 0x20000
    s_mov_b32 s98, 1024
    s_mov_b32 s99, 0x20000
    s_cmp_lt_u32 s40, 3
    s_cselect_b32 s56, 6, 5
    s_cselect_b32 s57, 0, 12
    s_mul_i32 s51, s42, s56
    s_add_u32 s57, s57, s51
    v_lshlrev_b32 v13, 1, v11
    v_xor_b32 v13, v13, v12
    v_lshlrev_b32 v13, 4, v13
    s_and_b32 s55, s3, 3
    v_lshrrev_b32 v10, 5, v2
    s_lshl_b32 s51, s40, 6
    s_add_u32 s51, s51, s41
    s_lshl_b32 s51, s51, 1
    s_add_u32 s87, s51, 655360
    s_lshl_b32 s61, s44, 9
    s_add_u32 s61, s61, 393216
    v_add_u32 v7, 139264, v3
    s_xor_b32 s59, s3, 4
    v_lshl_add_u32 v13, v11, 10, v13
    v_xor_b32 v15, 0x80, v13
    s_lshr_b32 s51, s59, 1
    s_lshl2_add_u32 s81, s42, s51
    s_and_b32 s53, s59, 1
    s_lshl3_add_u32 s81, s81, s53
    s_lshl4_add_u32 s81, s81, s90
    s_lshl_b32 s81, s81, 8
    s_and_b32 s82, s59, 4
    s_lshl1_add_u32 s53, s53, s82
    s_add_u32 s82, s57, s53
    s_and_b32 s51, s51, 1
    s_lshl1_add_u32 s82, s82, s51
    s_lshl4_add_u32 s82, s82, s90
    s_lshl_b32 s82, s82, 8
    s_cmp_lt_u32 s53, s56
    s_cselect_b32 s47, 0, 0x80000000
    s_add_u32 s53, s53, 1
    s_cmp_lt_u32 s53, s56
    s_cselect_b32 s49, 0, 0x80000000
    s_lshl_b32 s83, s59, 12
    s_lshl_b32 s86, s59, 11
    s_add_u32 s86, s86, 32768
    s_cmp_lt_u32 s3, 4
    s_cbranch_scc0 L_pvset
    s_cmp_eq_u32 s3, 0
    s_cbranch_scc0 L_nomlp
    v_mov_b32 v36, 0
    v_mov_b32 v37, 0
    v_mov_b32 v38, 0
    v_mov_b32 v39, -1
    s_mov_b32 exec_hi, 0
    buffer_store_dwordx4 v[36:39], v3, s[4:7], s61 offen sc1
    s_mov_b64 exec, -1
L_nomlp:
    v_and_b32 v28, 3, v2
    v_bfe_u32 v29, v2, 2, 1
    v_bfe_u32 v30, v2, 3, 1
    v_xor_b32 v29, v29, v30
    v_lshl_add_u32 v31, v28, 1, v29
    v_lshl_add_u32 v29, v31, 1, v30
    v_lshl_add_u32 v31, v30, 3, v31
    s_lshr_b32 s53, s3, 1
    s_and_b32 s52, s3, 1
    s_lshl_b32 s56, s53, 14
    v_lshl_add_u32 v31, v31, 10, s56
    v_xor_b32 v29, v29, v11
    v_xor_b32 v16, 0, v29
    v_lshl_add_u32 v16, v16, 4, v31
    v_xor_b32 v20, 0x10000, v16
    v_xor_b32 v17, 4, v29
    v_lshl_add_u32 v17, v17, 4, v31
    v_xor_b32 v21, 0x10000, v17
    v_xor_b32 v18, 8, v29
    v_lshl_add_u32 v18, v18, 4, v31
    v_xor_b32 v22, 0x10000, v18
    v_xor_b32 v19, 12, v29
    v_lshl_add_u32 v19, v19, 4, v31
    v_xor_b32 v23, 0x10000, v19
    s_lshl_b32 s56, s52, 14
    s_add_u32 s56, s56, 131072
    v_xor_b32 v29, v2, v11
    v_lshl_add_u32 v24, v29, 4, s56
    v_xor_b32 v25, 64, v24
    s_lshl_b32 s56, s52, 7
    s_add_u32 s56, s56, 131072
    v_lshl_add_u32 v5, v12, 3, s56
    s_lshl_b32 s56, s53, 2
    v_add_u32 v4, s56, v5
    s_lshl_b32 s56, s3, 10
    v_add_u32 v6, s56, v7
    s_mov_b32 s59, 0x49800000
    s_branch L_setdone
L_pvset:
    v_mul_u32_u24 v28, 33, v9
    v_add_u32 v28, s46, v28
    v_bfe_u32 v24, v28, 0, 1
    v_lshlrev_b32 v24, 14, v24
    v_bfe_u32 v29, v28, 1, 1
    v_lshl_or_b32 v24, v29, 30, v24
    v_bfe_u32 v25, v28, 2, 1
    v_lshlrev_b32 v25, 14, v25
    v_bfe_u32 v29, v28, 3, 1
    v_lshl_or_b32 v25, v29, 30, v25
    v_bfe_u32 v26, v28, 4, 1
    v_lshlrev_b32 v26, 14, v26
    v_bfe_u32 v29, v28, 5, 1
    v_lshl_or_b32 v26, v29, 30, v26
    v_bfe_u32 v27, v28, 6, 1
    v_lshlrev_b32 v27, 14, v27
    v_bfe_u32 v29, v28, 7, 1
    v_lshl_or_b32 v27, v29, 30, v27
    v_bfe_u32 v28, v2, 2, 2
    v_bfe_u32 v29, v2, 4, 1
    v_xor_b32 v29, v29, v10
    v_lshl_add_u32 v29, v28, 1, v29
    v_bfe_u32 v28, v2, 1, 1
    v_xor_b32 v28, v28, v10
    v_lshl_add_u32 v30, v29, 1, v28
    v_lshl_add_u32 v29, v10, 3, v29
    v_and_b32 v31, 1, v2
    v_lshlrev_b32 v31, 3, v31
    v_lshl_add_u32 v31, v29, 10, v31
    s_lshl_b32 s56, s55, 8
    v_add_u32 v31, s56, v31
    v_xor_b32 v16, 0, v30
    v_lshl_add_u32 v16, v16, 4, v31
    v_xor_b32 v17, 2, v30
    v_lshl_add_u32 v17, v17, 4, v31
    v_xor_b32 v18, 4, v30
    v_lshl_add_u32 v18, v18, 4, v31
    v_xor_b32 v19, 6, v30
    v_lshl_add_u32 v19, v19, 4, v31
    v_xor_b32 v20, 8, v30
    v_lshl_add_u32 v20, v20, 4, v31
    v_xor_b32 v21, 10, v30
    v_lshl_add_u32 v21, v21, 4, v31
    v_xor_b32 v22, 12, v30
    v_lshl_add_u32 v22, v22, 4, v31
    v_xor_b32 v23, 14, v30
    v_lshl_add_u32 v23, v23, 4, v31
    v_lshlrev_b32 v4, 10, v8
    v_lshl_add_u32 v4, v9, 4, v4
    s_lshl_b32 s80, s55, 13
    s_add_u32 s80, s80, 262144
    v_xor_b32 v5, v8, v9
    v_lshlrev_b32 v5, 4, v5
    v_lshl_add_u32 v5, v9, 8, v5
    s_and_b32 s56, s55, 1
    s_lshl_b32 s56, s56, 7
    s_lshr_b32 s51, s55, 1
    s_lshl_b32 s51, s51, 14
    s_add_u32 s56, s56, s51
    s_add_u32 s56, s56, 131072
    v_add_u32 v5, s56, v5
    s_lshl2_add_u32 s32, s44, s55
    s_lshl_b32 s32, s32, 3
    s_and_b32 s56, s44, 31
    s_xor_b32 s32, s32, s56
    s_lshl_b32 s32, s32, 10
    s_add_u32 s32, s32, 8388608
    s_xor_b32 s33, s32, 1024
    s_xor_b32 s34, s32, 2048
    s_xor_b32 s35, s32, 3072
    s_xor_b32 s36, s32, 4096
    s_xor_b32 s37, s32, 5120
    s_xor_b32 s38, s32, 6144
    s_xor_b32 s39, s32, 7168
    s_mov_b32 s54, 0x40004000
L_setdone:
    s_waitcnt lgkmcnt(0)
L_dma:
    s_waitcnt vmcnt(3)
    s_mov_b32 m0, s45
    s_addk_i32 s45, 8192
    buffer_load_dwordx4 v14, s[20:23], s50 offen nt lds
    s_add_u32 s50, s50, 0x100000
    v_xor_b32 v14, 16, v14
    s_sub_u32 s60, s60, 1
    s_cmp_lg_u32 s60, 3
    s_cbranch_scc1 L_dma
    s_waitcnt vmcnt(3)
    s_cmp_lt_u32 s3, 4
    s_barrier
    s_cbranch_scc1 L_qkw
    s_setprio 1
    buffer_load_dwordx4 v[64:67], v4, s[4:7], s80 offen offset:0 sc1
    buffer_load_dwordx4 v[68:71], v4, s[4:7], s80 offen offset:128 sc1
    ds_read_b64_tr_b16 v[128:129], v16 offset:0
    ds_read_b64_tr_b16 v[132:133], v17 offset:0
    ds_read_b64_tr_b16 v[136:137], v18 offset:0
    ds_read_b64_tr_b16 v[140:141], v19 offset:0
    buffer_load_dwordx4 v[72:75], v4, s[4:7], s80 offen offset:256 sc1
    buffer_load_dwordx4 v[76:79], v4, s[4:7], s80 offen offset:384 sc1
    ds_read_b64_tr_b16 v[144:145], v20 offset:0
    ds_read_b64_tr_b16 v[148:149], v21 offset:0
    ds_read_b64_tr_b16 v[152:153], v22 offset:0
    ds_read_b64_tr_b16 v[156:157], v23 offset:0
    buffer_load_dwordx4 v[80:83], v4, s[4:7], s80 offen offset:512 sc1
    buffer_load_dwordx4 v[84:87], v4, s[4:7], s80 offen offset:640 sc1
    ds_read_b64_tr_b16 v[160:161], v16 offset:16384
    ds_read_b64_tr_b16 v[164:165], v17 offset:16384
    ds_read_b64_tr_b16 v[168:169], v18 offset:16384
    ds_read_b64_tr_b16 v[172:173], v19 offset:16384
    buffer_load_dwordx4 v[88:91], v4, s[4:7], s80 offen offset:768 sc1
    buffer_load_dwordx4 v[92:95], v4, s[4:7], s80 offen offset:896 sc1
    ds_read_b64_tr_b16 v[176:177], v20 offset:16384
    ds_read_b64_tr_b16 v[180:181], v21 offset:16384
    ds_read_b64_tr_b16 v[184:185], v22 offset:16384
    ds_read_b64_tr_b16 v[188:189], v23 offset:16384
    ds_read_b64_tr_b16 v[130:131], v16 offset:32768
    ds_read_b64_tr_b16 v[134:135], v17 offset:32768
    ds_read_b64_tr_b16 v[138:139], v18 offset:32768
    ds_read_b64_tr_b16 v[142:143], v19 offset:32768
    ds_read_b64_tr_b16 v[146:147], v20 offset:32768
    ds_read_b64_tr_b16 v[150:151], v21 offset:32768
    ds_read_b64_tr_b16 v[154:155], v22 offset:32768
    ds_read_b64_tr_b16 v[158:159], v23 offset:32768
    ds_read_b64_tr_b16 v[162:163], v16 offset:49152
    ds_read_b64_tr_b16 v[166:167], v17 offset:49152
    ds_read_b64_tr_b16 v[170:171], v18 offset:49152
    ds_read_b64_tr_b16 v[174:175], v19 offset:49152
    ds_read_b64_tr_b16 v[178:179], v20 offset:49152
    ds_read_b64_tr_b16 v[182:183], v21 offset:49152
    ds_read_b64_tr_b16 v[186:187], v22 offset:49152
    ds_read_b64_tr_b16 v[190:191], v23 offset:49152
    v_xor_b32 v16, 0x10000, v16
    v_xor_b32 v17, 0x10000, v17
    v_xor_b32 v18, 0x10000, v18
    v_xor_b32 v19, 0x10000, v19
    v_xor_b32 v20, 0x10000, v20
    v_xor_b32 v21, 0x10000, v21
    v_xor_b32 v22, 0x10000, v22
    v_xor_b32 v23, 0x10000, v23
    s_mov_b32 m0, s45
    s_addk_i32 s45, 8192
    buffer_load_dwordx4 v14, s[20:23], s50 offen nt lds
    s_add_u32 s50, s50, 0x100000
    v_xor_b32 v14, 16, v14
    s_mov_b32 m0, s45
    s_addk_i32 s45, 8192
    buffer_load_dwordx4 v14, s[20:23], s50 offen nt lds
    s_add_u32 s50, s50, 0x100000
    v_xor_b32 v14, 16, v14
    s_mov_b32 m0, s45
    s_addk_i32 s45, 8192
    buffer_load_dwordx4 v14, s[20:23], s50 offen nt lds
    s_add_u32 s50, s50, 0x100000
    v_xor_b32 v14, 16, v14
    s_mov_b32 s48, 0
    s_mov_b64 s[88:89], -1
    s_waitcnt vmcnt(9)
L_qchk0:
    v_xor_b32 v64, v64, v24
    v_xor_b32 v65, v65, v25
    v_xor_b32 v66, v66, v26
    v_xor_b32 v67, v67, v27
    ds_write_b128 v5, v[64:67] offset:0
    v_xor_b32 v68, v68, v24
    v_xor_b32 v69, v69, v25
    v_xor_b32 v70, v70, v26
    v_xor_b32 v71, v71, v27
    ds_write_b128 v5, v[68:71] offset:2048
    v_or_b32 v29, v64, v65
    v_or3_b32 v29, v29, v66, v67
    v_or3_b32 v29, v29, v68, v69
    v_or3_b32 v29, v29, v70, v71
    v_and_b32 v29, s54, v29
    v_cmp_ne_u32 vcc, 0, v29
    s_nop 0
    s_and_b64 vcc, vcc, s[88:89]
    s_cbranch_vccnz L_qslow0
    s_waitcnt lgkmcnt(0)
    s_barrier
    s_waitcnt vmcnt(7)
L_qchk1:
    v_xor_b32 v72, v72, v24
    v_xor_b32 v73, v73, v25
    v_xor_b32 v74, v74, v26
    v_xor_b32 v75, v75, v27
    ds_write_b128 v5, v[72:75] offset:4096
    v_xor_b32 v76, v76, v24
    v_xor_b32 v77, v77, v25
    v_xor_b32 v78, v78, v26
    v_xor_b32 v79, v79, v27
    ds_write_b128 v5, v[76:79] offset:6144
    v_or_b32 v29, v72, v73
    v_or3_b32 v29, v29, v74, v75
    v_or3_b32 v29, v29, v76, v77
    v_or3_b32 v29, v29, v78, v79
    v_and_b32 v29, s54, v29
    v_cmp_ne_u32 vcc, 0, v29
    s_nop 0
    s_and_b64 vcc, vcc, s[88:89]
    s_cbranch_vccnz L_qslow1
    s_waitcnt lgkmcnt(0)
    s_barrier
    s_waitcnt vmcnt(5)
L_qchk2:
    v_xor_b32 v80, v80, v24
    v_xor_b32 v81, v81, v25
    v_xor_b32 v82, v82, v26
    v_xor_b32 v83, v83, v27
    ds_write_b128 v5, v[80:83] offset:8192
    v_xor_b32 v84, v84, v24
    v_xor_b32 v85, v85, v25
    v_xor_b32 v86, v86, v26
    v_xor_b32 v87, v87, v27
    ds_write_b128 v5, v[84:87] offset:10240
    v_or_b32 v29, v80, v81
    v_or3_b32 v29, v29, v82, v83
    v_or3_b32 v29, v29, v84, v85
    v_or3_b32 v29, v29, v86, v87
    v_and_b32 v29, s54, v29
    v_cmp_ne_u32 vcc, 0, v29
    s_nop 0
    s_and_b64 vcc, vcc, s[88:89]
    s_cbranch_vccnz L_qslow2
    s_waitcnt vmcnt(3)
L_qchk3:
    v_xor_b32 v88, v88, v24
    v_xor_b32 v89, v89, v25
    v_xor_b32 v90, v90, v26
    v_xor_b32 v91, v91, v27
    ds_write_b128 v5, v[88:91] offset:12288
    v_xor_b32 v92, v92, v24
    v_xor_b32 v93, v93, v25
    v_xor_b32 v94, v94, v26
    v_xor_b32 v95, v95, v27
    ds_write_b128 v5, v[92:95] offset:14336
    v_or_b32 v29, v88, v89
    v_or3_b32 v29, v29, v90, v91
    v_or3_b32 v29, v29, v92, v93
    v_or3_b32 v29, v29, v94, v95
    v_and_b32 v29, s54, v29
    v_cmp_ne_u32 vcc, 0, v29
    s_nop 0
    s_and_b64 vcc, vcc, s[88:89]
    s_cbranch_vccnz L_qslow3
    s_waitcnt lgkmcnt(0)
    s_barrier
    s_setprio 0
    s_mov_b32 m0, s83
    s_addk_i32 s83, 1024
    buffer_load_dwordx4 v13, s[28:31], s81 offen nt lds
    s_addk_i32 s81, 8192
    s_mov_b32 m0, s83
    s_addk_i32 s83, 1024
    buffer_load_dwordx4 v15, s[28:31], s81 offen nt lds
    s_addk_i32 s81, 8192
    s_mov_b32 m0, s83
    s_addk_i32 s83, 1024
    buffer_load_dwordx4 v13, s[28:31], s81 offen nt lds
    s_addk_i32 s81, 8192
    s_mov_b32 m0, s83
    s_addk_i32 s83, 1024
    buffer_load_dwordx4 v15, s[28:31], s81 offen nt lds
    s_addk_i32 s81, 8192
    s_mov_b32 m0, s86
    s_addk_i32 s86, 1024
    v_or_b32 v13, s47, v13
    buffer_load_dwordx4 v13, s[92:95], s82 offen nt lds
    s_addk_i32 s82, 8192
    s_mov_b32 m0, s86
    s_addk_i32 s86, 1024
    v_or_b32 v15, s49, v15
    buffer_load_dwordx4 v15, s[92:95], s82 offen nt lds
    s_addk_i32 s82, 8192
    ds_read_b64_tr_b16 v[192:193], v16 offset:0
    ds_read_b64_tr_b16 v[196:197], v17 offset:0
    ds_read_b64_tr_b16 v[200:201], v18 offset:0
    ds_read_b64_tr_b16 v[204:205], v19 offset:0
    ds_read_b64_tr_b16 v[208:209], v20 offset:0
    ds_read_b64_tr_b16 v[212:213], v21 offset:0
    ds_read_b64_tr_b16 v[216:217], v22 offset:0
    ds_read_b64_tr_b16 v[220:221], v23 offset:0
    ds_read_b64_tr_b16 v[224:225], v16 offset:16384
    ds_read_b64_tr_b16 v[228:229], v17 offset:16384
    ds_read_b64_tr_b16 v[232:233], v18 offset:16384
    ds_read_b64_tr_b16 v[236:237], v19 offset:16384
    ds_read_b64_tr_b16 v[240:241], v20 offset:16384
    ds_read_b64_tr_b16 v[244:245], v21 offset:16384
    ds_read_b64_tr_b16 v[248:249], v22 offset:16384
    ds_read_b64_tr_b16 v[252:253], v23 offset:16384
    s_waitcnt vmcnt(6)
    s_barrier
    ds_read_b64_tr_b16 v[194:195], v16 offset:32768
    ds_read_b64_tr_b16 v[198:199], v17 offset:32768
    ds_read_b64_tr_b16 v[202:203], v18 offset:32768
    ds_read_b64_tr_b16 v[206:207], v19 offset:32768
    ds_read_b64_tr_b16 v[210:211], v20 offset:32768
    ds_read_b64_tr_b16 v[214:215], v21 offset:32768
    ds_read_b64_tr_b16 v[218:219], v22 offset:32768
    ds_read_b64_tr_b16 v[222:223], v23 offset:32768
    ds_read_b64_tr_b16 v[226:227], v16 offset:49152
    ds_read_b64_tr_b16 v[230:231], v17 offset:49152
    ds_read_b64_tr_b16 v[234:235], v18 offset:49152
    ds_read_b64_tr_b16 v[238:239], v19 offset:49152
    ds_read_b64_tr_b16 v[242:243], v20 offset:49152
    ds_read_b64_tr_b16 v[246:247], v21 offset:49152
    ds_read_b64_tr_b16 v[250:251], v22 offset:49152
    ds_read_b64_tr_b16 v[254:255], v23 offset:49152
    s_barrier
    s_waitcnt lgkmcnt(0)
    s_barrier
    ds_read_b128 v[32:35], v7 offset:0
    ds_read_b128 v[36:39], v7 offset:2048
    ds_read_b128 v[40:43], v7 offset:4096
    ds_read_b128 v[44:47], v7 offset:6144
    ds_read_b128 v[48:51], v7 offset:1024
    ds_read_b128 v[52:55], v7 offset:3072
    ds_read_b128 v[56:59], v7 offset:5120
    ds_read_b128 v[60:63], v7 offset:7168
    s_waitcnt lgkmcnt(7)
    v_mfma_f32_16x16x32_bf16 v[64:67], v[32:35], v[128:131], 0
    v_mfma_f32_16x16x32_bf16 v[68:71], v[32:35], v[132:135], 0
    v_mfma_f32_16x16x32_bf16 v[72:75], v[32:35], v[136:139], 0
    v_mfma_f32_16x16x32_bf16 v[76:79], v[32:35], v[140:143], 0
    v_mfma_f32_16x16x32_bf16 v[80:83], v[32:35], v[144:147], 0
    v_mfma_f32_16x16x32_bf16 v[84:87], v[32:35], v[148:151], 0
    v_mfma_f32_16x16x32_bf16 v[88:91], v[32:35], v[152:155], 0
    v_mfma_f32_16x16x32_bf16 v[92:95], v[32:35], v[156:159], 0
    s_waitcnt lgkmcnt(6)
    v_mfma_f32_16x16x32_bf16 v[64:67], v[36:39], v[160:163], v[64:67]
    v_mfma_f32_16x16x32_bf16 v[68:71], v[36:39], v[164:167], v[68:71]
    v_mfma_f32_16x16x32_bf16 v[72:75], v[36:39], v[168:171], v[72:75]
    v_mfma_f32_16x16x32_bf16 v[76:79], v[36:39], v[172:175], v[76:79]
    v_mfma_f32_16x16x32_bf16 v[80:83], v[36:39], v[176:179], v[80:83]
    v_mfma_f32_16x16x32_bf16 v[84:87], v[36:39], v[180:183], v[84:87]
    v_mfma_f32_16x16x32_bf16 v[88:91], v[36:39], v[184:187], v[88:91]
    v_mfma_f32_16x16x32_bf16 v[92:95], v[36:39], v[188:191], v[92:95]
    s_waitcnt lgkmcnt(5)
    v_mfma_f32_16x16x32_bf16 v[64:67], v[40:43], v[192:195], v[64:67]
    v_mfma_f32_16x16x32_bf16 v[68:71], v[40:43], v[196:199], v[68:71]
    v_mfma_f32_16x16x32_bf16 v[72:75], v[40:43], v[200:203], v[72:75]
    v_mfma_f32_16x16x32_bf16 v[76:79], v[40:43], v[204:207], v[76:79]
    v_mfma_f32_16x16x32_bf16 v[80:83], v[40:43], v[208:211], v[80:83]
    v_mfma_f32_16x16x32_bf16 v[84:87], v[40:43], v[212:215], v[84:87]
    v_mfma_f32_16x16x32_bf16 v[88:91], v[40:43], v[216:219], v[88:91]
    v_mfma_f32_16x16x32_bf16 v[92:95], v[40:43], v[220:223], v[92:95]
    s_waitcnt lgkmcnt(0)
    v_mfma_f32_16x16x32_bf16 v[64:67], v[44:47], v[224:227], v[64:67]
    v_mfma_f32_16x16x32_bf16 v[68:71], v[44:47], v[228:231], v[68:71]
    v_mfma_f32_16x16x32_bf16 v[72:75], v[44:47], v[232:235], v[72:75]
    v_mfma_f32_16x16x32_bf16 v[76:79], v[44:47], v[236:239], v[76:79]
    v_mfma_f32_16x16x32_bf16 v[80:83], v[44:47], v[240:243], v[80:83]
    v_mfma_f32_16x16x32_bf16 v[84:87], v[44:47], v[244:247], v[84:87]
    v_mfma_f32_16x16x32_bf16 v[88:91], v[44:47], v[248:251], v[88:91]
    v_mfma_f32_16x16x32_bf16 v[92:95], v[44:47], v[252:255], v[92:95]
    v_mfma_f32_16x16x32_bf16 v[96:99], v[48:51], v[128:131], 0
    s_cmp_eq_u32 s3, 7
    s_cbranch_scc0 L_nohp
    v_mov_b32 v1, s46
    s_mov_b64 exec, 1
    buffer_store_dword v1, v3, s[4:7], s87 offen offset:64
    s_mov_b64 exec, -1
L_nohp:
    v_mfma_f32_16x16x32_bf16 v[100:103], v[48:51], v[132:135], 0
    v_mfma_f32_16x16x32_bf16 v[104:107], v[48:51], v[136:139], 0
    v_mfma_f32_16x16x32_bf16 v[108:111], v[48:51], v[140:143], 0
    v_mfma_f32_16x16x32_bf16 v[112:115], v[48:51], v[144:147], 0
    v_mfma_f32_16x16x32_bf16 v[116:119], v[48:51], v[148:151], 0
    v_cvt_pk_bf16_f32 v32, v64, v68
    v_cvt_pk_bf16_f32 v33, v72, v76
    v_mfma_f32_16x16x32_bf16 v[120:123], v[48:51], v[152:155], 0
    v_cvt_pk_bf16_f32 v34, v80, v84
    v_mfma_f32_16x16x32_bf16 v[124:127], v[48:51], v[156:159], 0
    v_cvt_pk_bf16_f32 v35, v88, v92
    v_xor_b32 v32, v32, v24
    v_mfma_f32_16x16x32_bf16 v[96:99], v[52:55], v[160:163], v[96:99]
    v_xor_b32 v33, v33, v25
    v_mfma_f32_16x16x32_bf16 v[100:103], v[52:55], v[164:167], v[100:103]
    v_xor_b32 v34, v34, v26
    v_xor_b32 v35, v35, v27
    v_mfma_f32_16x16x32_bf16 v[104:107], v[52:55], v[168:171], v[104:107]
    buffer_store_dwordx4 v[32:35], v3, s[4:7], s32 offen sc1
    v_mfma_f32_16x16x32_bf16 v[108:111], v[52:55], v[172:175], v[108:111]
    v_cvt_pk_bf16_f32 v36, v65, v69
    v_cvt_pk_bf16_f32 v37, v73, v77
    v_mfma_f32_16x16x32_bf16 v[112:115], v[52:55], v[176:179], v[112:115]
    v_cvt_pk_bf16_f32 v38, v81, v85
    v_mfma_f32_16x16x32_bf16 v[116:119], v[52:55], v[180:183], v[116:119]
    v_cvt_pk_bf16_f32 v39, v89, v93
    v_xor_b32 v36, v36, v24
    v_mfma_f32_16x16x32_bf16 v[120:123], v[52:55], v[184:187], v[120:123]
    v_xor_b32 v37, v37, v25
    v_mfma_f32_16x16x32_bf16 v[124:127], v[52:55], v[188:191], v[124:127]
    v_xor_b32 v38, v38, v26
    v_xor_b32 v39, v39, v27
    v_mfma_f32_16x16x32_bf16 v[96:99], v[56:59], v[192:195], v[96:99]
    buffer_store_dwordx4 v[36:39], v3, s[4:7], s33 offen sc1
    v_mfma_f32_16x16x32_bf16 v[100:103], v[56:59], v[196:199], v[100:103]
    v_cvt_pk_bf16_f32 v40, v66, v70
    v_cvt_pk_bf16_f32 v41, v74, v78
    v_mfma_f32_16x16x32_bf16 v[104:107], v[56:59], v[200:203], v[104:107]
    v_cvt_pk_bf16_f32 v42, v82, v86
    v_mfma_f32_16x16x32_bf16 v[108:111], v[56:59], v[204:207], v[108:111]
    v_cvt_pk_bf16_f32 v43, v90, v94
    v_xor_b32 v40, v40, v24
    v_mfma_f32_16x16x32_bf16 v[112:115], v[56:59], v[208:211], v[112:115]
    v_xor_b32 v41, v41, v25
    v_mfma_f32_16x16x32_bf16 v[116:119], v[56:59], v[212:215], v[116:119]
    v_xor_b32 v42, v42, v26
    v_xor_b32 v43, v43, v27
    v_mfma_f32_16x16x32_bf16 v[120:123], v[56:59], v[216:219], v[120:123]
    buffer_store_dwordx4 v[40:43], v3, s[4:7], s34 offen sc1
    v_mfma_f32_16x16x32_bf16 v[124:127], v[56:59], v[220:223], v[124:127]
    v_cvt_pk_bf16_f32 v44, v67, v71
    v_cvt_pk_bf16_f32 v45, v75, v79
    v_mfma_f32_16x16x32_bf16 v[96:99], v[60:63], v[224:227], v[96:99]
    v_cvt_pk_bf16_f32 v46, v83, v87
    v_mfma_f32_16x16x32_bf16 v[100:103], v[60:63], v[228:231], v[100:103]
    v_cvt_pk_bf16_f32 v47, v91, v95
    v_xor_b32 v44, v44, v24
    v_mfma_f32_16x16x32_bf16 v[104:107], v[60:63], v[232:235], v[104:107]
    v_xor_b32 v45, v45, v25
    v_mfma_f32_16x16x32_bf16 v[108:111], v[60:63], v[236:239], v[108:111]
    v_xor_b32 v46, v46, v26
    v_xor_b32 v47, v47, v27
    v_mfma_f32_16x16x32_bf16 v[112:115], v[60:63], v[240:243], v[112:115]
    buffer_store_dwordx4 v[44:47], v3, s[4:7], s35 offen sc1
    v_mfma_f32_16x16x32_bf16 v[116:119], v[60:63], v[244:247], v[116:119]
    v_mfma_f32_16x16x32_bf16 v[120:123], v[60:63], v[248:251], v[120:123]
    v_mfma_f32_16x16x32_bf16 v[124:127], v[60:63], v[252:255], v[124:127]
    v_cvt_pk_bf16_f32 v64, v96, v100
    v_cvt_pk_bf16_f32 v65, v104, v108
    s_nop 3
    v_cvt_pk_bf16_f32 v66, v112, v116
    s_nop 0
    v_cvt_pk_bf16_f32 v67, v120, v124
    v_xor_b32 v64, v64, v24
    v_xor_b32 v65, v65, v25
    v_xor_b32 v66, v66, v26
    v_xor_b32 v67, v67, v27
    buffer_store_dwordx4 v[64:67], v3, s[4:7], s36 offen sc1
    v_cvt_pk_bf16_f32 v68, v97, v101
    v_cvt_pk_bf16_f32 v69, v105, v109
    v_cvt_pk_bf16_f32 v70, v113, v117
    v_cvt_pk_bf16_f32 v71, v121, v125
    v_xor_b32 v68, v68, v24
    v_xor_b32 v69, v69, v25
    v_xor_b32 v70, v70, v26
    v_xor_b32 v71, v71, v27
    buffer_store_dwordx4 v[68:71], v3, s[4:7], s37 offen sc1
    v_cvt_pk_bf16_f32 v72, v98, v102
    v_cvt_pk_bf16_f32 v73, v106, v110
    v_cvt_pk_bf16_f32 v74, v114, v118
    v_cvt_pk_bf16_f32 v75, v122, v126
    v_xor_b32 v72, v72, v24
    v_xor_b32 v73, v73, v25
    v_xor_b32 v74, v74, v26
    v_xor_b32 v75, v75, v27
    buffer_store_dwordx4 v[72:75], v3, s[4:7], s38 offen sc1
    v_cvt_pk_bf16_f32 v76, v99, v103
    v_cvt_pk_bf16_f32 v77, v107, v111
    v_cvt_pk_bf16_f32 v78, v115, v119
    v_cvt_pk_bf16_f32 v79, v123, v127
    v_xor_b32 v76, v76, v24
    v_xor_b32 v77, v77, v25
    v_xor_b32 v78, v78, v26
    v_xor_b32 v79, v79, v27
    buffer_store_dwordx4 v[76:79], v3, s[4:7], s39 offen sc1
    s_barrier
    s_branch L_e
L_qkw:
    ds_read_b128 v[128:131], v16 offset:0
    ds_read_b128 v[132:135], v17 offset:0
    ds_read_b128 v[136:139], v18 offset:0
    ds_read_b128 v[140:143], v19 offset:0
    ds_read_b128 v[144:147], v16 offset:256
    ds_read_b128 v[148:151], v17 offset:256
    ds_read_b128 v[152:155], v18 offset:256
    ds_read_b128 v[156:159], v19 offset:256
    ds_read_b128 v[160:163], v16 offset:512
    ds_read_b128 v[164:167], v17 offset:512
    ds_read_b128 v[168:171], v18 offset:512
    ds_read_b128 v[172:175], v19 offset:512
    ds_read_b128 v[176:179], v16 offset:768
    ds_read_b128 v[180:183], v17 offset:768
    ds_read_b128 v[184:187], v18 offset:768
    ds_read_b128 v[188:191], v19 offset:768
    ds_read_b128 v[192:195], v16 offset:32768
    ds_read_b128 v[196:199], v17 offset:32768
    ds_read_b128 v[200:203], v18 offset:32768
    ds_read_b128 v[204:207], v19 offset:32768
    ds_read_b128 v[208:211], v16 offset:33024
    ds_read_b128 v[212:215], v17 offset:33024
    ds_read_b128 v[216:219], v18 offset:33024
    ds_read_b128 v[220:223], v19 offset:33024
    ds_read_b128 v[224:227], v16 offset:33280
    ds_read_b128 v[228:231], v17 offset:33280
    ds_read_b128 v[232:235], v18 offset:33280
    ds_read_b128 v[236:239], v19 offset:33280
    ds_read_b128 v[240:243], v16 offset:33536
    ds_read_b128 v[244:247], v17 offset:33536
    ds_read_b128 v[248:251], v18 offset:33536
    ds_read_b128 v[252:255], v19 offset:33536
    s_mov_b32 m0, s45
    s_addk_i32 s45, 8192
    buffer_load_dwordx4 v14, s[20:23], s50 offen nt lds
    s_add_u32 s50, s50, 0x100000
    v_xor_b32 v14, 16, v14
    s_mov_b32 m0, s45
    s_addk_i32 s45, 8192
    buffer_load_dwordx4 v14, s[20:23], s50 offen nt lds
    s_add_u32 s50, s50, 0x100000
    v_xor_b32 v14, 16, v14
    s_mov_b32 m0, s45
    s_addk_i32 s45, 8192
    buffer_load_dwordx4 v14, s[20:23], s50 offen nt lds
    s_add_u32 s50, s50, 0x100000
    v_xor_b32 v14, 16, v14
    s_cmp_eq_u32 s3, 3
    s_cbranch_scc0 L_nosg
    v_mov_b32 v1, s46
    s_mov_b64 exec, 1
    buffer_store_dword v1, v3, s[4:7], s87 offen
    s_mov_b64 exec, -1
L_nosg:
    v_mov_b32 v29, 0x41a00000
    s_waitcnt vmcnt(4) lgkmcnt(0)
    s_barrier
    ds_read_b128 v[64:67], v24 offset:0
    ds_read_b128 v[68:71], v25 offset:1024
    ds_read_b128 v[72:75], v24 offset:2048
    s_waitcnt lgkmcnt(2)
    v_mfma_f32_16x16x32_bf16 v[32:35], v[128:131], v[64:67], 0
    ds_read_b128 v[76:79], v25 offset:3072
    v_mfma_f32_16x16x32_bf16 v[36:39], v[192:195], v[64:67], 0
    s_waitcnt lgkmcnt(2)
    v_mfma_f32_16x16x32_bf16 v[32:35], v[132:135], v[68:71], v[32:35]
    s_barrier
    ds_read_b128 v[80:83], v24 offset:4096
    v_mfma_f32_16x16x32_bf16 v[36:39], v[196:199], v[68:71], v[36:39]
    ds_read_b128 v[128:131], v20 offset:0
    s_waitcnt lgkmcnt(3)
    v_mfma_f32_16x16x32_bf16 v[32:35], v[136:139], v[72:75], v[32:35]
    ds_read_b128 v[84:87], v25 offset:5120
    v_mfma_f32_16x16x32_bf16 v[36:39], v[200:203], v[72:75], v[36:39]
    ds_read_b128 v[132:135], v21 offset:0
    s_waitcnt lgkmcnt(4)
    v_mfma_f32_16x16x32_bf16 v[32:35], v[140:143], v[76:79], v[32:35]
    ds_read_b128 v[88:91], v24 offset:6144
    v_mfma_f32_16x16x32_bf16 v[36:39], v[204:207], v[76:79], v[36:39]
    ds_read_b128 v[136:139], v22 offset:0
    s_waitcnt lgkmcnt(5)
    v_mfma_f32_16x16x32_bf16 v[32:35], v[144:147], v[80:83], v[32:35]
    ds_read_b128 v[92:95], v25 offset:7168
    v_mfma_f32_16x16x32_bf16 v[36:39], v[208:211], v[80:83], v[36:39]
    ds_read_b128 v[140:143], v23 offset:0
    s_waitcnt lgkmcnt(5)
    v_mfma_f32_16x16x32_bf16 v[32:35], v[148:151], v[84:87], v[32:35]
    s_barrier
    ds_read_b128 v[96:99], v24 offset:8192
    v_mfma_f32_16x16x32_bf16 v[36:39], v[212:215], v[84:87], v[36:39]
    ds_read_b128 v[144:147], v20 offset:256
    s_waitcnt lgkmcnt(5)
    v_mfma_f32_16x16x32_bf16 v[32:35], v[152:155], v[88:91], v[32:35]
    ds_read_b128 v[100:103], v25 offset:9216
    v_mfma_f32_16x16x32_bf16 v[36:39], v[216:219], v[88:91], v[36:39]
    ds_read_b128 v[148:151], v21 offset:256
    s_waitcnt lgkmcnt(5)
    v_mfma_f32_16x16x32_bf16 v[32:35], v[156:159], v[92:95], v[32:35]
    ds_read_b128 v[104:107], v24 offset:10240
    v_mfma_f32_16x16x32_bf16 v[36:39], v[220:223], v[92:95], v[36:39]
    ds_read_b128 v[152:155], v22 offset:256
    s_waitcnt lgkmcnt(5)
    v_mfma_f32_16x16x32_bf16 v[32:35], v[160:163], v[96:99], v[32:35]
    ds_read_b128 v[108:111], v25 offset:11264
    v_mfma_f32_16x16x32_bf16 v[36:39], v[224:227], v[96:99], v[36:39]
    ds_read_b128 v[156:159], v23 offset:256
    s_waitcnt lgkmcnt(5)
    v_mfma_f32_16x16x32_bf16 v[32:35], v[164:167], v[100:103], v[32:35]
    ds_read_b128 v[112:115], v24 offset:12288
    v_mfma_f32_16x16x32_bf16 v[36:39], v[228:231], v[100:103], v[36:39]
    ds_read_b128 v[160:163], v20 offset:512
    s_waitcnt lgkmcnt(5)
    v_mfma_f32_16x16x32_bf16 v[32:35], v[168:171], v[104:107], v[32:35]
    ds_read_b128 v[116:119], v25 offset:13312
    v_mfma_f32_16x16x32_bf16 v[36:39], v[232:235], v[104:107], v[36:39]
    ds_read_b128 v[164:167], v21 offset:512
    s_waitcnt lgkmcnt(5)
    v_mfma_f32_16x16x32_bf16 v[32:35], v[172:175], v[108:111], v[32:35]
    ds_read_b128 v[120:123], v24 offset:14336
    v_mfma_f32_16x16x32_bf16 v[36:39], v[236:239], v[108:111], v[36:39]
    ds_read_b128 v[168:171], v22 offset:512
    s_waitcnt lgkmcnt(5)
    v_mfma_f32_16x16x32_bf16 v[32:35], v[176:179], v[112:115], v[32:35]
    ds_read_b128 v[124:127], v25 offset:15360
    v_mfma_f32_16x16x32_bf16 v[36:39], v[240:243], v[112:115], v[36:39]
    ds_read_b128 v[172:175], v23 offset:512
    s_waitcnt lgkmcnt(5)
    v_mfma_f32_16x16x32_bf16 v[32:35], v[180:183], v[116:119], v[32:35]
    v_mfma_f32_16x16x32_bf16 v[36:39], v[244:247], v[116:119], v[36:39]
    ds_read_b128 v[176:179], v20 offset:768
    s_waitcnt lgkmcnt(4)
    v_mfma_f32_16x16x32_bf16 v[32:35], v[184:187], v[120:123], v[32:35]
    v_mfma_f32_16x16x32_bf16 v[36:39], v[248:251], v[120:123], v[36:39]
    ds_read_b128 v[180:183], v21 offset:768
    s_waitcnt lgkmcnt(3)
    v_mfma_f32_16x16x32_bf16 v[32:35], v[188:191], v[124:127], v[32:35]
    v_mfma_f32_16x16x32_bf16 v[36:39], v[252:255], v[124:127], v[36:39]
    ds_read_b128 v[184:187], v22 offset:768
    ds_read_b128 v[188:191], v23 offset:768
    v_mfma_f32_16x16x32_bf16 v[40:43], v[128:131], v[64:67], 0
    v_mfma_f32_16x16x32_bf16 v[40:43], v[132:135], v[68:71], v[40:43]
    v_mfma_f32_16x16x32_bf16 v[40:43], v[136:139], v[72:75], v[40:43]
    v_mfma_f32_16x16x32_bf16 v[40:43], v[140:143], v[76:79], v[40:43]
    v_mfma_f32_16x16x32_bf16 v[40:43], v[144:147], v[80:83], v[40:43]
    v_mfma_f32_16x16x32_bf16 v[40:43], v[148:151], v[84:87], v[40:43]
    v_mfma_f32_16x16x32_bf16 v[40:43], v[152:155], v[88:91], v[40:43]
    v_mfma_f32_16x16x32_bf16 v[40:43], v[156:159], v[92:95], v[40:43]
    v_mfma_f32_16x16x32_bf16 v[40:43], v[160:163], v[96:99], v[40:43]
    v_mfma_f32_16x16x32_bf16 v[40:43], v[164:167], v[100:103], v[40:43]
    v_mfma_f32_16x16x32_bf16 v[40:43], v[168:171], v[104:107], v[40:43]
    s_waitcnt vmcnt(0)
    s_barrier
    ds_read_b128 v[192:195], v20 offset:32768
    s_waitcnt lgkmcnt(5)
    v_mfma_f32_16x16x32_bf16 v[40:43], v[172:175], v[108:111], v[40:43]
    ds_read_b128 v[196:199], v21 offset:32768
    s_waitcnt lgkmcnt(5)
    v_mfma_f32_16x16x32_bf16 v[40:43], v[176:179], v[112:115], v[40:43]
    ds_read_b128 v[200:203], v22 offset:32768
    s_waitcnt lgkmcnt(5)
    v_mfma_f32_16x16x32_bf16 v[40:43], v[180:183], v[116:119], v[40:43]
    ds_read_b128 v[204:207], v23 offset:32768
    s_waitcnt lgkmcnt(5)
    v_mfma_f32_16x16x32_bf16 v[40:43], v[184:187], v[120:123], v[40:43]
    ds_read_b128 v[208:211], v20 offset:33024
    s_waitcnt lgkmcnt(5)
    v_mfma_f32_16x16x32_bf16 v[40:43], v[188:191], v[124:127], v[40:43]
    ds_read_b128 v[212:215], v21 offset:33024
    s_waitcnt lgkmcnt(5)
    v_mfma_f32_16x16x32_bf16 v[44:47], v[192:195], v[64:67], 0
    ds_read_b128 v[216:219], v22 offset:33024
    s_waitcnt lgkmcnt(5)
    v_mfma_f32_16x16x32_bf16 v[44:47], v[196:199], v[68:71], v[44:47]
    ds_read_b128 v[220:223], v23 offset:33024
    s_waitcnt lgkmcnt(5)
    v_mfma_f32_16x16x32_bf16 v[44:47], v[200:203], v[72:75], v[44:47]
    ds_read_b128 v[224:227], v20 offset:33280
    s_waitcnt lgkmcnt(5)
    v_mfma_f32_16x16x32_bf16 v[44:47], v[204:207], v[76:79], v[44:47]
    ds_read_b128 v[228:231], v21 offset:33280
    s_waitcnt lgkmcnt(5)
    v_mfma_f32_16x16x32_bf16 v[44:47], v[208:211], v[80:83], v[44:47]
    ds_read_b128 v[232:235], v22 offset:33280
    s_waitcnt lgkmcnt(5)
    v_mfma_f32_16x16x32_bf16 v[44:47], v[212:215], v[84:87], v[44:47]
    ds_read_b128 v[236:239], v23 offset:33280
    s_waitcnt lgkmcnt(5)
    v_mfma_f32_16x16x32_bf16 v[44:47], v[216:219], v[88:91], v[44:47]
    ds_read_b128 v[240:243], v20 offset:33536
    s_waitcnt lgkmcnt(5)
    v_mfma_f32_16x16x32_bf16 v[44:47], v[220:223], v[92:95], v[44:47]
    ds_read_b128 v[244:247], v21 offset:33536
    s_waitcnt lgkmcnt(5)
    v_mfma_f32_16x16x32_bf16 v[44:47], v[224:227], v[96:99], v[44:47]
    ds_read_b128 v[248:251], v22 offset:33536
    s_waitcnt lgkmcnt(5)
    v_mfma_f32_16x16x32_bf16 v[44:47], v[228:231], v[100:103], v[44:47]
    ds_read_b128 v[252:255], v23 offset:33536
    s_waitcnt lgkmcnt(5)
    v_mfma_f32_16x16x32_bf16 v[44:47], v[232:235], v[104:107], v[44:47]
    v_max3_f32 v28, v32, v33, v34
    s_waitcnt lgkmcnt(4)
    v_mfma_f32_16x16x32_bf16 v[44:47], v[236:239], v[108:111], v[44:47]
    v_max3_f32 v28, v28, v35, v36
    s_waitcnt lgkmcnt(3)
    v_mfma_f32_16x16x32_bf16 v[44:47], v[240:243], v[112:115], v[44:47]
    v_max3_f32 v28, v28, v37, v38
    s_waitcnt lgkmcnt(2)
    v_mfma_f32_16x16x32_bf16 v[44:47], v[244:247], v[116:119], v[44:47]
    v_max3_f32 v28, v28, v39, v40
    s_waitcnt lgkmcnt(1)
    v_mfma_f32_16x16x32_bf16 v[44:47], v[248:251], v[120:123], v[44:47]
    v_max3_f32 v28, v28, v41, v42
    s_waitcnt lgkmcnt(0)
    v_mfma_f32_16x16x32_bf16 v[44:47], v[252:255], v[124:127], v[44:47]
    v_max_f32 v28, v28, v43
    s_nop 6
    v_max3_f32 v28, v28, v44, v45
    v_max3_f32 v28, v28, v46, v47
    v_mov_b32 v30, v28
    s_nop 1
    v_permlane16_swap_b32 v28, v30
    v_max_f32 v28, v28, v30
    v_mov_b32 v30, v28
    s_nop 1
    v_permlane32_swap_b32 v28, v30
    v_max_f32 v28, v28, v30
    ds_write_b32 v4, v28
    s_waitcnt lgkmcnt(0)
    s_barrier
    ds_read_b64 v[30:31], v5
    s_waitcnt lgkmcnt(0)
    v_max_f32 v28, v30, v31
    v_fma_f32 v28, v28, s59, v29
    v_fma_f32 v32, v32, s59, -v28
    v_exp_f32 v32, v32
    v_fma_f32 v33, v33, s59, -v28
    v_exp_f32 v33, v33
    v_fma_f32 v34, v34, s59, -v28
    v_exp_f32 v34, v34
    v_fma_f32 v35, v35, s59, -v28
    v_exp_f32 v35, v35
    v_fma_f32 v36, v36, s59, -v28
    v_exp_f32 v36, v36
    v_fma_f32 v37, v37, s59, -v28
    v_exp_f32 v37, v37
    v_fma_f32 v38, v38, s59, -v28
    v_exp_f32 v38, v38
    v_fma_f32 v39, v39, s59, -v28
    v_exp_f32 v39, v39
    v_cvt_pk_bf16_f32 v56, v32, v33
    v_cvt_pk_bf16_f32 v57, v34, v35
    v_cvt_pk_bf16_f32 v58, v36, v37
    v_cvt_pk_bf16_f32 v59, v38, v39
    ds_write_b128 v6, v[56:59] offset:0
    v_fma_f32 v40, v40, s59, -v28
    v_exp_f32 v40, v40
    v_fma_f32 v41, v41, s59, -v28
    v_exp_f32 v41, v41
    v_fma_f32 v42, v42, s59, -v28
    v_exp_f32 v42, v42
    v_fma_f32 v43, v43, s59, -v28
    v_exp_f32 v43, v43
    v_fma_f32 v44, v44, s59, -v28
    v_exp_f32 v44, v44
    v_fma_f32 v45, v45, s59, -v28
    v_exp_f32 v45, v45
    v_fma_f32 v46, v46, s59, -v28
    v_exp_f32 v46, v46
    v_fma_f32 v47, v47, s59, -v28
    v_exp_f32 v47, v47
    v_cvt_pk_bf16_f32 v60, v40, v41
    v_cvt_pk_bf16_f32 v61, v42, v43
    v_cvt_pk_bf16_f32 v62, v44, v45
    v_cvt_pk_bf16_f32 v63, v46, v47
    ds_write_b128 v6, v[60:63] offset:4096
    s_cmp_lt_u32 s3, 2
    s_waitcnt lgkmcnt(0)
    s_barrier
    s_cbranch_scc0 L_qkidle
    ds_read_b128 v[32:35], v6 offset:0
    ds_read_b128 v[36:39], v6 offset:2048
    ds_read_b128 v[40:43], v6 offset:4096
    ds_read_b128 v[44:47], v6 offset:6144
    v_mov_b32 v48, 0x3f803f80
    v_mov_b32 v49, 0x3f803f80
    v_mov_b32 v50, 0x3f803f80
    v_mov_b32 v51, 0x3f803f80
    v_mov_b32 v30, s46
    v_mov_b32 v31, s46
    s_lshl_b32 s56, s3, 4
    s_lshl_b32 s56, 0xffff, s56
    s_waitcnt lgkmcnt(0)
    v_mfma_f32_16x16x32_bf16 v[52:55], v[48:51], v[32:35], 0
    v_mfma_f32_16x16x32_bf16 v[52:55], v[48:51], v[36:39], v[52:55]
    v_mfma_f32_16x16x32_bf16 v[52:55], v[48:51], v[40:43], v[52:55]
    v_mfma_f32_16x16x32_bf16 v[52:55], v[48:51], v[44:47], v[52:55]
    s_nop 7
    v_mov_b32 v29, v52
    s_mov_b32 exec_lo, s56
    s_mov_b32 exec_hi, 0
    buffer_store_dwordx4 v[28:31], v3, s[4:7], s61 offen sc1
    s_mov_b64 exec, -1
L_qkidle:
L_qkid2:
    s_barrier
    s_mov_b32 m0, s83
    s_addk_i32 s83, 1024
    buffer_load_dwordx4 v13, s[28:31], s81 offen nt lds
    s_addk_i32 s81, 8192
    s_mov_b32 m0, s83
    s_addk_i32 s83, 1024
    buffer_load_dwordx4 v15, s[28:31], s81 offen nt lds
    s_addk_i32 s81, 8192
    s_mov_b32 m0, s83
    s_addk_i32 s83, 1024
    buffer_load_dwordx4 v13, s[28:31], s81 offen nt lds
    s_addk_i32 s81, 8192
    s_mov_b32 m0, s83
    s_addk_i32 s83, 1024
    buffer_load_dwordx4 v15, s[28:31], s81 offen nt lds
    s_addk_i32 s81, 8192
    s_mov_b32 m0, s86
    s_addk_i32 s86, 1024
    v_or_b32 v13, s47, v13
    buffer_load_dwordx4 v13, s[92:95], s82 offen nt lds
    s_addk_i32 s82, 8192
    s_mov_b32 m0, s86
    s_addk_i32 s86, 1024
    v_or_b32 v15, s49, v15
    buffer_load_dwordx4 v15, s[92:95], s82 offen nt lds
    s_addk_i32 s82, 8192
    s_cmp_eq_u32 s3, 2
    s_cbranch_scc0 L_gud
    s_lshl_b32 s50, s42, 11
    s_add_u32 s50, s50, 458752
    v_lshlrev_b32 v1, 2, v2
    s_mov_b32 s48, 0
gu_4:
    buffer_load_dword v40, v1, s[4:7], s50 offen offset:0 sc1
    buffer_load_dword v41, v1, s[4:7], s50 offen offset:256 sc1
    buffer_load_dword v42, v1, s[4:7], s50 offen offset:512 sc1
    buffer_load_dword v43, v1, s[4:7], s50 offen offset:768 sc1
    buffer_load_dword v44, v1, s[4:7], s50 offen offset:1024 sc1
    buffer_load_dword v45, v1, s[4:7], s50 offen offset:1280 sc1
    buffer_load_dword v46, v1, s[4:7], s50 offen offset:1536 sc1
    buffer_load_dword v47, v1, s[4:7], s50 offen offset:1792 sc1
    s_waitcnt vmcnt(0)
    v_add_f32 v40, v40, v44
    v_add_f32 v41, v41, v45
    v_add_f32 v42, v42, v46
    v_add_f32 v43, v43, v47
    v_add_f32 v40, v40, v42
    v_add_f32 v41, v41, v43
    v_cvt_pk_bf16_f32 v40, v40, v40
    v_and_b32 v40, 0xffff0000, v40
    v_cvt_pk_bf16_f32 v41, v41, v41
    v_and_b32 v41, 0xffff0000, v41
    v_mul_f32 v40, v40, v41
    v_cmp_u_f32 vcc, v40, v40
    s_cbranch_vccnz rt_5
ok_6:
    v_cvt_pk_bf16_f32 v40, v40, v40
    v_lshlrev_b32 v1, 1, v2
    ds_write_b16 v1, v40 offset:49152
L_gud:
    s_waitcnt vmcnt(0)
L_e:
    v_lshrrev_b32 v30, 2, v2
    v_and_b32 v31, 7, v30
    v_xor_b32 v31, s3, v31
    v_lshlrev_b32 v31, 5, v31
    v_lshl_add_u32 v31, v30, 8, v31
    v_and_b32 v30, 3, v2
    v_lshl_add_u32 v52, v30, 3, v31
    s_lshl_b32 s85, s42, 10
    s_add_u32 s85, s85, 589824
    v_lshlrev_b32 v53, 2, v2
    v_lshlrev_b32 v55, 4, v11
    s_lshl_b32 s50, s90, 5
    s_add_u32 s50, s50, s42
    s_lshl3_add_u32 s50, s50, s3
    s_lshl_b32 s50, s50, 6
    s_add_u32 s50, s50, 786432
    s_lshr_b32 s53, s40, 1
    s_xor_b32 s54, s53, s90
    s_and_b32 s53, s42, 2
    s_or_b32 s54, s54, s53
    s_xor_b32 s53, s3, 2
    s_or_b32 s54, s54, s53
    s_and_b32 s53, s42, 1
    s_lshl1_add_u32 s52, s40, s53
    s_and_b32 s51, s52, 3
    s_lshl_b32 s51, s51, 7
    s_lshl_b32 s52, s52, 6
    s_lshl_b32 s57, s90, 14
    s_add_u32 s57, s57, s51
    s_add_u32 s57, s57, 786432
    v_lshlrev_b32 v57, 3, v9
    v_lshl_add_u32 v57, v11, 1, v57
    v_add_u32 v57, s52, v57
    v_lshlrev_b32 v56, 11, v8
    v_lshl_add_u32 v56, v9, 4, v56
    s_waitcnt vmcnt(8) lgkmcnt(0)
    s_barrier
    global_load_ushort v58, v57, s[12:13]
    s_add_u32 s61, s87, 0x1000
    ds_read_b128 v[36:39], v55 offset:49152
    ds_read_b128 v[40:43], v55 offset:49216
    ds_read_b64_tr_b16 v[144:145], v52 offset:32768
    ds_read_b64_tr_b16 v[146:147], v52 offset:36864
    ds_read_b64_tr_b16 v[148:149], v52 offset:40960
    ds_read_b64_tr_b16 v[150:151], v52 offset:45056
    ds_read_b64_tr_b16 v[128:129], v52 offset:0
    ds_read_b64_tr_b16 v[130:131], v52 offset:4096
    ds_read_b64_tr_b16 v[132:133], v52 offset:8192
    ds_read_b64_tr_b16 v[134:135], v52 offset:12288
    ds_read_b64_tr_b16 v[136:137], v52 offset:16384
    ds_read_b64_tr_b16 v[138:139], v52 offset:20480
    ds_read_b64_tr_b16 v[140:141], v52 offset:24576
    ds_read_b64_tr_b16 v[142:143], v52 offset:28672
    v_cmp_eq_u32 vcc, 0, v12
    s_waitcnt lgkmcnt(0)
    s_nop 0
    v_cndmask_b32 v36, 0, v36, vcc
    v_cndmask_b32 v37, 0, v37, vcc
    v_cndmask_b32 v38, 0, v38, vcc
    v_cndmask_b32 v39, 0, v39, vcc
    v_cndmask_b32 v40, 0, v40, vcc
    v_cndmask_b32 v41, 0, v41, vcc
    v_cndmask_b32 v42, 0, v42, vcc
    v_cndmask_b32 v43, 0, v43, vcc
    v_mfma_f32_16x16x32_bf16 v[92:95], v[36:39], v[144:147], 0
    s_nop 0
    v_mfma_f32_16x16x32_bf16 v[92:95], v[40:43], v[148:151], v[92:95]
    s_xor_b32 s51, s3, 4
    s_lshl3_add_u32 s58, s44, s51
    s_lshl_b32 s58, s58, 2
    s_add_u32 s58, s58, 360448
    v_mov_b32 v4, s46
    s_waitcnt vmcnt(0)
    v_lshlrev_b32 v58, 16, v58
    s_movk_i32 s48, 64
L_q4:
    buffer_load_dwordx4 v[36:39], v3, s[4:7], s85 offen sc1
    s_sub_u32 s48, s48, 1
    s_cbranch_scc1 L_p4x
    s_waitcnt vmcnt(0)
    v_cmp_eq_u32 vcc, -1, v39
    s_cbranch_vccnz L_q4
    s_branch L_p4a
    s_movk_i32 s48, 40
    buffer_load_dwordx4 v[36:39], v3, s[4:7], s85 offen sc1
L_p4:
    buffer_load_dwordx4 v[40:43], v3, s[4:7], s85 offen sc1
    s_waitcnt vmcnt(1)
    v_cmp_eq_u32 vcc, -1, v39
    s_cbranch_vccz L_p4a
    buffer_load_dwordx4 v[36:39], v3, s[4:7], s85 offen sc1
    s_sub_u32 s48, s48, 1
    s_cbranch_scc1 L_p4x
    s_waitcnt vmcnt(1)
    v_cmp_eq_u32 vcc, -1, v43
    s_cbranch_vccnz L_p4
    v_mfma_f32_16x16x32_bf16 v[64:67], v[40:43], v[128:131], v[92:95]
    v_mfma_f32_16x16x32_bf16 v[68:71], v[40:43], v[132:135], 0
    v_mfma_f32_16x16x32_bf16 v[72:75], v[40:43], v[136:139], 0
    v_mfma_f32_16x16x32_bf16 v[76:79], v[40:43], v[140:143], 0
    s_branch L_p4j
L_p4x:
    s_mov_b32 s48, 0
h4_7:
    buffer_load_dwordx4 v[36:39], v3, s[4:7], s85 offen sc1
    s_waitcnt vmcnt(0)
L_p4a:
    v_mfma_f32_16x16x32_bf16 v[64:67], v[36:39], v[128:131], v[92:95]
    v_mfma_f32_16x16x32_bf16 v[68:71], v[36:39], v[132:135], 0
    v_mfma_f32_16x16x32_bf16 v[72:75], v[36:39], v[136:139], 0
    v_mfma_f32_16x16x32_bf16 v[76:79], v[36:39], v[140:143], 0
L_p4j:
    s_nop 4
    v_add_f32_dpp v80, v64, v65 quad_perm:[0,1,2,3] row_mask:0x1 bank_mask:0xf
    v_add_f32_dpp v81, v66, v67 quad_perm:[0,1,2,3] row_mask:0x1 bank_mask:0xf
    s_nop 0
    v_add_f32_dpp v80, v68, v69 quad_perm:[0,1,2,3] row_mask:0x2 bank_mask:0xf
    v_add_f32_dpp v81, v70, v71 quad_perm:[0,1,2,3] row_mask:0x2 bank_mask:0xf
    s_nop 0
    v_add_f32_dpp v80, v72, v73 quad_perm:[0,1,2,3] row_mask:0x4 bank_mask:0xf
    v_add_f32_dpp v81, v74, v75 quad_perm:[0,1,2,3] row_mask:0x4 bank_mask:0xf
    s_nop 0
    v_add_f32_dpp v80, v76, v77 quad_perm:[0,1,2,3] row_mask:0x8 bank_mask:0xf
    v_add_f32_dpp v81, v78, v79 quad_perm:[0,1,2,3] row_mask:0x8 bank_mask:0xf
    v_add_f32 v82, v80, v81
    v_add_f32 v80, v80, v81
    s_nop 1
    v_permlane16_swap_b32 v80, v82
    v_add_f32 v81, v80, v82
    v_add_f32 v80, v80, v82
    s_nop 1
    v_permlane32_swap_b32 v80, v81
    v_add_f32 v80, v80, v81
    v_cmp_u_f32 vcc, v80, v80
    s_cbranch_vccnz rt_8
ok_9:
    s_mov_b64 exec, 0xffff
    buffer_store_dword v80, v53, s[4:7], s50 offen sc1
    s_cmp_lt_u32 s3, 4
    s_cbranch_scc1 L_nodf
    s_mov_b64 exec, 1
    buffer_store_dword v4, v3, s[4:7], s58 offen sc1
    s_mov_b64 exec, -1
L_nodf:
    s_mov_b64 exec, -1
    s_cmp_eq_u32 s54, 0
    s_cbranch_scc0 L_fin
    s_waitcnt vmcnt(0)
    s_movk_i32 s48, 64
    buffer_load_dwordx4 v[32:35], v56, s[4:7], s57 offen offset:0 sc1
    buffer_load_dwordx4 v[36:39], v56, s[4:7], s57 offen offset:512 sc1
    buffer_load_dwordx4 v[40:43], v56, s[4:7], s57 offen offset:1024 sc1
    buffer_load_dwordx4 v[44:47], v56, s[4:7], s57 offen offset:1536 sc1
L_p5:
    buffer_load_dwordx4 v[64:67], v56, s[4:7], s57 offen offset:0 sc1
    buffer_load_dwordx4 v[68:71], v56, s[4:7], s57 offen offset:512 sc1
    buffer_load_dwordx4 v[72:75], v56, s[4:7], s57 offen offset:1024 sc1
    buffer_load_dwordx4 v[76:79], v56, s[4:7], s57 offen offset:1536 sc1
    s_waitcnt vmcnt(4)
    v_max3_u32 v5, v32, v36, v40
    v_max_u32 v5, v5, v44
    v_cmp_eq_u32 vcc, -1, v5
    s_cbranch_vccz L_p5a
    buffer_load_dwordx4 v[96:99], v56, s[4:7], s57 offen offset:0 sc1
    buffer_load_dwordx4 v[100:103], v56, s[4:7], s57 offen offset:512 sc1
    buffer_load_dwordx4 v[104:107], v56, s[4:7], s57 offen offset:1024 sc1
    buffer_load_dwordx4 v[108:111], v56, s[4:7], s57 offen offset:1536 sc1
    s_waitcnt vmcnt(4)
    v_max3_u32 v5, v64, v68, v72
    v_max_u32 v5, v5, v76
    v_cmp_eq_u32 vcc, -1, v5
    s_cbranch_vccz L_p5b
    buffer_load_dwordx4 v[32:35], v56, s[4:7], s57 offen offset:0 sc1
    buffer_load_dwordx4 v[36:39], v56, s[4:7], s57 offen offset:512 sc1
    buffer_load_dwordx4 v[40:43], v56, s[4:7], s57 offen offset:1024 sc1
    buffer_load_dwordx4 v[44:47], v56, s[4:7], s57 offen offset:1536 sc1
    s_sub_u32 s48, s48, 1
    s_cbranch_scc1 L_p5x
    s_waitcnt vmcnt(4)
    v_max3_u32 v5, v96, v100, v104
    v_max_u32 v5, v5, v108
    v_cmp_eq_u32 vcc, -1, v5
    s_cbranch_vccnz L_p5
    v_pk_add_f32 v[112:113], v[96:97], v[104:105]
    v_pk_add_f32 v[114:115], v[98:99], v[106:107]
    v_pk_add_f32 v[116:117], v[100:101], v[108:109]
    v_pk_add_f32 v[118:119], v[102:103], v[110:111]
    s_branch L_p5j
L_p5b:
    v_pk_add_f32 v[112:113], v[64:65], v[72:73]
    v_pk_add_f32 v[114:115], v[66:67], v[74:75]
    v_pk_add_f32 v[116:117], v[68:69], v[76:77]
    v_pk_add_f32 v[118:119], v[70:71], v[78:79]
    s_branch L_p5j
L_p5x:
    s_mov_b32 s48, 0
h5_10:
    buffer_load_dwordx4 v[32:35], v56, s[4:7], s57 offen offset:0 sc1
    buffer_load_dwordx4 v[36:39], v56, s[4:7], s57 offen offset:512 sc1
    buffer_load_dwordx4 v[40:43], v56, s[4:7], s57 offen offset:1024 sc1
    buffer_load_dwordx4 v[44:47], v56, s[4:7], s57 offen offset:1536 sc1
    s_waitcnt vmcnt(0)
L_p5a:
    v_pk_add_f32 v[112:113], v[32:33], v[40:41]
    v_pk_add_f32 v[114:115], v[34:35], v[42:43]
    v_pk_add_f32 v[116:117], v[36:37], v[44:45]
    v_pk_add_f32 v[118:119], v[38:39], v[46:47]
L_p5j:
    v_pk_add_f32 v[112:113], v[112:113], v[116:117]
    v_pk_add_f32 v[114:115], v[114:115], v[118:119]
    s_mov_b32 s88, 0x00ff00ff
    s_mov_b32 s89, s88
    v_permlane32_swap_b32 v112, v114
    v_permlane32_swap_b32 v113, v115
    v_add_f32 v112, v112, v114
    v_add_f32 v113, v113, v115
    v_cmp_u_f32 vcc, v112, v113
    s_nop 0
    v_permlane16_swap_b32 v112, v113
    s_cbranch_vccnz rt_11
ok_12:
    v_add_f32 v112, v112, v113
    s_nop 1
    v_add_f32_dpp v112, v112, v112 row_ror:8 row_mask:0xf bank_mask:0xf
    s_mov_b64 exec, s[88:89]
    v_add_f32 v112, v112, v58
    v_cvt_pk_bf16_f32 v112, v112, v112
    buffer_store_short v112, v57, s[96:99], 0 offen
    s_cmp_eq_u32 s42, 0
    s_cbranch_scc0 L_fin
    s_mov_b64 exec, 1
    buffer_store_dword v4, v3, s[4:7], 0 offen
L_fin:
L_end:
    s_endpgm
rt_2:
    s_add_u32 s48, s48, 1
    s_cmp_eq_u32 s48, 8
    s_cbranch_scc0 rt_2_a
    s_mov_b64 exec, 0xffff
    buffer_store_dword v28, v58, s[4:7], s54 offen sc1
    s_mov_b64 exec, -1
rt_2_a:
    s_cmp_lt_u32 s48, 12
    s_cbranch_scc1 rt_2_b
    v_swap_b32 v14, v15
rt_2_b:
    s_cmp_lt_u32 s48, 65536
    s_cbranch_scc1 h1_1
    s_branch ok_3
L_ptslow:
    s_add_u32 s48, s48, 1
    s_cmp_ge_u32 s48, 65536
    s_cbranch_scc1 L_ptok
    s_cmp_lt_u32 s48, 8
    s_cbranch_scc1 L_ptre
    s_cmp_eq_u32 s3, 5
    s_cbranch_scc0 L_gug1
    buffer_store_dwordx2 v[90:91], v53, s[4:7], s84 offen sc1
L_gug1:
    s_lshl_b32 s50, s90, 2
    s_lshl_b32 s51, s3, 9
    s_add_u32 s50, s50, s51
    s_add_u32 s50, s50, 360448
    v_lshlrev_b32 v5, 5, v12
    buffer_load_dword v5, v5, s[4:7], s50 offen sc1
    s_waitcnt vmcnt(0)
    v_cmp_ne_u32 vcc, s46, v5
    s_nop 0
    s_cmp_eq_u64 vcc, 0
    s_cselect_b64 s[88:89], 0, -1
L_ptre:
    buffer_load_dwordx4 v[96:99], v7, s[4:7], s80 offen sc1
    buffer_load_dwordx4 v[100:103], v7, s[4:7], s81 offen sc1
    buffer_load_dwordx4 v[104:107], v7, s[4:7], s82 offen sc1
    buffer_load_dwordx4 v[108:111], v7, s[4:7], s83 offen sc1
    s_branch L_pt
L_qslow0:
    s_movk_i32 s60, 0
    s_branch L_qslow
L_qre0:
    buffer_load_dwordx4 v[64:67], v4, s[4:7], s80 offen offset:0 sc1
    buffer_load_dwordx4 v[68:71], v4, s[4:7], s80 offen offset:128 sc1
    buffer_load_dwordx4 v[72:75], v4, s[4:7], s80 offen offset:256 sc1
    buffer_load_dwordx4 v[76:79], v4, s[4:7], s80 offen offset:384 sc1
    buffer_load_dwordx4 v[80:83], v4, s[4:7], s80 offen offset:512 sc1
    buffer_load_dwordx4 v[84:87], v4, s[4:7], s80 offen offset:640 sc1
    buffer_load_dwordx4 v[88:91], v4, s[4:7], s80 offen offset:768 sc1
    buffer_load_dwordx4 v[92:95], v4, s[4:7], s80 offen offset:896 sc1
    s_waitcnt vmcnt(0)
    s_branch L_qchk0
L_qslow1:
    s_movk_i32 s60, 1
    s_branch L_qslow
L_qre1:
    buffer_load_dwordx4 v[72:75], v4, s[4:7], s80 offen offset:256 sc1
    buffer_load_dwordx4 v[76:79], v4, s[4:7], s80 offen offset:384 sc1
    buffer_load_dwordx4 v[80:83], v4, s[4:7], s80 offen offset:512 sc1
    buffer_load_dwordx4 v[84:87], v4, s[4:7], s80 offen offset:640 sc1
    buffer_load_dwordx4 v[88:91], v4, s[4:7], s80 offen offset:768 sc1
    buffer_load_dwordx4 v[92:95], v4, s[4:7], s80 offen offset:896 sc1
    s_waitcnt vmcnt(0)
    s_branch L_qchk1
L_qslow2:
    s_movk_i32 s60, 2
    s_branch L_qslow
L_qre2:
    buffer_load_dwordx4 v[80:83], v4, s[4:7], s80 offen offset:512 sc1
    buffer_load_dwordx4 v[84:87], v4, s[4:7], s80 offen offset:640 sc1
    buffer_load_dwordx4 v[88:91], v4, s[4:7], s80 offen offset:768 sc1
    buffer_load_dwordx4 v[92:95], v4, s[4:7], s80 offen offset:896 sc1
    s_waitcnt vmcnt(0)
    s_branch L_qchk2
L_qslow3:
    s_movk_i32 s60, 3
    s_branch L_qslow
L_qre3:
    buffer_load_dwordx4 v[88:91], v4, s[4:7], s80 offen offset:768 sc1
    buffer_load_dwordx4 v[92:95], v4, s[4:7], s80 offen offset:896 sc1
    s_waitcnt vmcnt(0)
    s_branch L_qchk3
L_qslow:
    s_add_u32 s48, s48, 1
    s_cmp_lt_u32 s48, 8
    s_cbranch_scc1 L_qre
    s_mov_b32 s51, 327680
    buffer_load_dwordx4 v[96:99], v3, s[4:7], s51 offen sc1
    buffer_load_dwordx4 v[100:103], v3, s[4:7], s51 offen offset:1024 sc1
    s_waitcnt vmcnt(0)
    v_xor_b32 v96, s46, v96
    v_xor_b32 v97, s46, v97
    v_xor_b32 v98, s46, v98
    v_xor_b32 v99, s46, v99
    v_xor_b32 v100, s46, v100
    v_xor_b32 v101, s46, v101
    v_xor_b32 v102, s46, v102
    v_xor_b32 v103, s46, v103
    v_or_b32 v96, v96, v97
    v_or3_b32 v96, v96, v98, v99
    v_or3_b32 v96, v96, v100, v101
    v_or3_b32 v96, v96, v102, v103
    v_cmp_ne_u32 vcc, 0, v96
    s_nop 0
    s_cmp_eq_u64 vcc, 0
    s_cselect_b64 s[88:89], 0, -1
    s_cmp_ge_u32 s48, 65536
    s_cselect_b64 s[88:89], 0, s[88:89]
L_qre:
    s_waitcnt vmcnt(0) lgkmcnt(0)
    s_cmp_eq_u32 s60, 0
    s_cbranch_scc1 L_qre0
    s_cmp_eq_u32 s60, 1
    s_cbranch_scc1 L_qre1
    s_cmp_eq_u32 s60, 2
    s_cbranch_scc1 L_qre2
    s_branch L_qre3
rt_5:
    s_add_u32 s48, s48, 1
    s_cmp_lt_u32 s48, 65536
    s_cbranch_scc1 gu_4
    s_branch ok_6
rt_8:
    s_add_u32 s48, s48, 1
    s_xor_b32 s85, s85, 0x10000
    s_and_b32 s87, s48, 31
    s_cmp_eq_u32 s87, 1
    s_cbranch_scc0 rt_8_o
    s_mov_b64 exec, 1
    buffer_store_dword v4, v3, s[4:7], s58 offen sc1
    s_mov_b64 exec, -1
rt_8_o:
    s_cmp_lt_u32 s48, 65536
    s_cbranch_scc1 h4_7
    s_branch ok_9
rt_11:
    s_add_u32 s48, s48, 1
    s_cmp_lt_u32 s48, 65536
    s_cbranch_scc1 h5_10
    s_branch ok_12
L_codeend:
.fill (16384 + 512 - (L_codeend - parallel_sum__compressed_kv_cla__glu_gated_bilinear__decode_kernel))/4, 4, 0xbf800000
.section .rodata,"a"
.p2align 6
.amdhsa_kernel parallel_sum__compressed_kv_cla__glu_gated_bilinear__decode_kernel
  .amdhsa_next_free_vgpr 256
  .amdhsa_next_free_sgpr 102
  .amdhsa_accum_offset 256
  .amdhsa_group_segment_fixed_size 0
  .amdhsa_kernarg_size 104
  .amdhsa_user_sgpr_count 2
  .amdhsa_user_sgpr_kernarg_segment_ptr 1
  .amdhsa_system_sgpr_workgroup_id_x 1
  .amdhsa_float_denorm_mode_32 3
.end_amdhsa_kernel
```
